```python
import torch

def _softmax(x, axis=-1):
    return torch.softmax(x, dim=axis)
def _gelu(x):
    return torch.nn.functional.gelu(x, approximate="tanh")
def _silu(x):
    return torch.nn.functional.silu(x)
def _sigmoid(x):
    return torch.sigmoid(x)
def _layernorm(x, axis=-1, eps=1e-5):
    m = x.mean(dim=axis, keepdim=True)
    v = x.var(dim=axis, keepdim=True, unbiased=False)
    return (x - m) / torch.sqrt(v + eps)
def _scatter_add(tgt, idx, src, axis=0):
    return tgt.clone().index_add_(axis, idx, src)
def _segment_sum(src, seg, n):
    out = torch.zeros((n,) + src.shape[1:], dtype=src.dtype)
    return out.index_add_(0, seg, src)
def _pad(x, pw):
    flat = tuple(v for pair in reversed(pw) for v in pair)
    return torch.nn.functional.pad(x, flat)

kernel_name = 'standalone__molecular_angular_gemnet__graph'

def setup_inputs():

    _w = (lambda a: (lambda t: t.to(torch.bfloat16) if t.is_floating_point() else t)(torch.as_tensor(a)))
    N, deg, De, L = 25000, 16, 4, 3
    E = N * deg
    T = E * deg
    NR = 8
    dist = torch.rand(E).to(float)
    angle = (torch.rand(T) * torch.pi).to(float)
    centers = torch.linspace(0.0, 1.0, NR).to(float)
    ang_freq = torch.arange(1, L + 1).to(float)
    return {
        "m": _w((lambda *s: torch.randn(*s, dtype=torch.bfloat16) * 0.05)(E, De)),
        "idx_in": _w((lambda lo, hi, *s: torch.randint(lo, hi, s))(0, E, T).to(torch.int64)),
        "idx_out": _w((lambda lo, hi, *s: torch.randint(lo, hi, s))(0, E, T).to(torch.int64)),
        "dist": _w(dist),
        "angle": _w(angle),
        "centers": _w(centers),
        "ang_freq": _w(ang_freq),
        "w_rbf": _w((lambda *s: torch.randn(*s, dtype=torch.bfloat16) * 0.4)(NR, De)),
        "w_sbf": _w((lambda *s: torch.randn(*s, dtype=torch.bfloat16) * 0.4)(NR * L, De)),
        "w_down": _w((lambda *s: torch.randn(*s, dtype=torch.bfloat16) * 0.4)(De, De)),
        "w_up": _w((lambda *s: torch.randn(*s, dtype=torch.bfloat16) * 0.4)(De, De)),
    }

def reference(m, idx_in, idx_out, dist, angle, centers, ang_freq, w_rbf, w_sbf, w_down, w_up):
    E, De = m.shape[0], m.shape[1]
    NR = centers.shape[0]
    L = ang_freq.shape[0]
    rbf = torch.exp(-10.0 * (dist[:, None] - centers[None, :]) ** 2)
    cbf = torch.cos(ang_freq[None, :] * angle[:, None])
    rbf_t = rbf[idx_out]
    sbf = torch.reshape(rbf_t[:, :, None] * cbf[:, None, :], (-1, NR * L))
    x = (m[idx_in] @ w_down) * (sbf @ w_sbf)
    agg = _segment_sum(x, idx_out, E)
    return m + (agg @ w_up) * (rbf @ w_rbf)
```

```asm
; @launch kernel=part_kernel grid=(512,1,1) block=(512,1,1) lds=76032
; @launch kernel=acc_kernel grid=(256,1,1) block=(1024,1,1) lds=163840
.amdgcn_target "amdgcn-amd-amdhsa--gfx950"
.text
.globl part_kernel
.p2align 8
.type part_kernel,@function
part_kernel:
    s_cmp_ge_u32 s2, 512
    s_cbranch_scc1 p1_done
    s_load_dwordx4 s[4:7], s[0:1], 8
    s_load_dwordx2 s[28:29], s[0:1], 32
    s_load_dwordx2 s[30:31], s[0:1], 104
    s_load_dwordx2 s[40:41], s[0:1], 0
    s_load_dwordx2 s[44:45], s[0:1], 24
    v_lshlrev_b32 v1, 4, v0
    v_lshlrev_b32 v2, 3, v0
    v_mov_b32 v3, 3
    v_readfirstlane_b32 s3, v0
    s_lshr_b32 s3, s3, 6
    s_mul_i32 s32, s2, 50000
    s_mul_i32 s33, s2, 25000
    s_mov_b32 s34, 2747900
    s_mov_b32 s35, 4294961044
    v_lshlrev_b32 v4, 2, v0
    v_mov_b32 v5, 0
    v_cmp_gt_u32 vcc, 256, v0
    s_mov_b64 exec, vcc
    ds_write_b32 v4, v5
    s_mov_b64 exec, -1
    v_add_u32 v12, 1024, v1
    v_add_u32 v13, 66560, v1
    v_cmp_gt_u32 vcc, 80, v0
    s_nop 1
    v_cndmask_b32 v14, 2.0, v1, vcc
    s_waitcnt lgkmcnt(0)
    s_barrier
    s_mov_b32 s8, s4
    s_and_b32 s9, s5, 0xffff
    s_mov_b32 s10, 25600000
    s_mov_b32 s11, 0x00020000
    s_mov_b32 s12, s6
    s_and_b32 s13, s7, 0xffff
    s_mov_b32 s14, 25600000
    s_mov_b32 s15, 0x00020000
    s_mov_b32 s16, s28
    s_and_b32 s17, s29, 0xffff
    s_mov_b32 s18, 12800000
    s_mov_b32 s19, 0x00020000
    s_mov_b32 s20, s30
    s_and_b32 s21, s31, 0xffff
    s_mov_b32 s22, 38404096
    s_mov_b32 s23, 0x00020000
    s_add_u32 s30, s30, 41943040
    s_addc_u32 s31, s31, 0
    s_mov_b32 s24, s30
    s_and_b32 s25, s31, 0xffff
    s_mov_b32 s26, 524288
    s_mov_b32 s27, 0x00020000
    s_setprio 1
    s_cmp_ge_u32 s2, 256
    s_cbranch_scc1 p1_lowprio
    s_setprio 3
p1_lowprio:
    s_cmp_lg_u32 s3, 0
    s_cbranch_scc1 p1_l3skip
    s_mov_b32 exec_lo, 4294967295
    s_mov_b32 exec_hi, 2097151
    s_add_u32 s36, s32, 49152
    s_add_u32 s37, s33, 24576
    buffer_load_dwordx4 v[80:83], v1, s[12:15], s36 offen
    buffer_load_dwordx4 v[76:79], v1, s[8:11], s36 offen
    buffer_load_dwordx2 v[84:85], v2, s[16:19], s37 offen
    s_mov_b64 exec, -1
p1_l3skip:
    s_add_u32 s36, s32, 0
    s_add_u32 s37, s33, 0
    buffer_load_dwordx4 v[20:23], v1, s[12:15], s36 offen
    buffer_load_dwordx4 v[16:19], v1, s[8:11], s36 offen
    buffer_load_dwordx2 v[24:25], v2, s[16:19], s37 offen
    s_add_u32 s36, s32, 8192
    s_add_u32 s37, s33, 4096
    buffer_load_dwordx4 v[30:33], v1, s[12:15], s36 offen
    buffer_load_dwordx4 v[26:29], v1, s[8:11], s36 offen
    buffer_load_dwordx2 v[34:35], v2, s[16:19], s37 offen
    s_add_u32 s36, s32, 16384
    s_add_u32 s37, s33, 8192
    buffer_load_dwordx4 v[40:43], v1, s[12:15], s36 offen
    buffer_load_dwordx4 v[36:39], v1, s[8:11], s36 offen
    buffer_load_dwordx2 v[44:45], v2, s[16:19], s37 offen
    s_add_u32 s36, s32, 24576
    s_add_u32 s37, s33, 12288
    buffer_load_dwordx4 v[50:53], v1, s[12:15], s36 offen
    buffer_load_dwordx4 v[46:49], v1, s[8:11], s36 offen
    buffer_load_dwordx2 v[54:55], v2, s[16:19], s37 offen
    s_add_u32 s36, s32, 32768
    s_add_u32 s37, s33, 16384
    buffer_load_dwordx4 v[60:63], v1, s[12:15], s36 offen
    buffer_load_dwordx4 v[56:59], v1, s[8:11], s36 offen
    buffer_load_dwordx2 v[64:65], v2, s[16:19], s37 offen
    s_add_u32 s36, s32, 40960
    s_add_u32 s37, s33, 20480
    buffer_load_dwordx4 v[70:73], v1, s[12:15], s36 offen
    buffer_load_dwordx4 v[66:69], v1, s[8:11], s36 offen
    buffer_load_dwordx2 v[74:75], v2, s[16:19], s37 offen
    s_setprio 2
    s_waitcnt vmcnt(15)
    v_mul_hi_u32_u24 v4, s34, v20
    v_lshlrev_b32 v20, 2, v20
    v_mad_i32_i24 v20, v4, s35, v20
    v_lshl_or_b32 v16, v16, 13, v20
    v_lshlrev_b32 v20, 2, v4
    ds_add_rtn_u32 v88, v20, v3
    v_mul_hi_u32_u24 v5, s34, v21
    v_lshlrev_b32 v21, 2, v21
    v_mad_i32_i24 v21, v5, s35, v21
    v_lshl_or_b32 v17, v17, 13, v21
    v_lshlrev_b32 v21, 2, v5
    ds_add_rtn_u32 v89, v21, v3
    v_mul_hi_u32_u24 v6, s34, v22
    v_lshlrev_b32 v22, 2, v22
    v_mad_i32_i24 v22, v6, s35, v22
    v_lshl_or_b32 v18, v18, 13, v22
    v_lshlrev_b32 v22, 2, v6
    ds_add_rtn_u32 v90, v22, v3
    v_mul_hi_u32_u24 v7, s34, v23
    v_lshlrev_b32 v23, 2, v23
    v_mad_i32_i24 v23, v7, s35, v23
    v_lshl_or_b32 v19, v19, 13, v23
    v_lshlrev_b32 v23, 2, v7
    ds_add_rtn_u32 v91, v23, v3
    s_cmp_lg_u32 s3, 0
    s_cbranch_scc1 p1_h3skip
    s_mov_b32 exec_lo, 4294967295
    s_mov_b32 exec_hi, 2097151
    v_mul_hi_u32_u24 v4, s34, v80
    v_lshlrev_b32 v80, 2, v80
    v_mad_i32_i24 v80, v4, s35, v80
    v_lshl_or_b32 v76, v76, 13, v80
    v_lshlrev_b32 v80, 2, v4
    ds_add_rtn_u32 v112, v80, v3
    v_mul_hi_u32_u24 v5, s34, v81
    v_lshlrev_b32 v81, 2, v81
    v_mad_i32_i24 v81, v5, s35, v81
    v_lshl_or_b32 v77, v77, 13, v81
    v_lshlrev_b32 v81, 2, v5
    ds_add_rtn_u32 v113, v81, v3
    v_mul_hi_u32_u24 v6, s34, v82
    v_lshlrev_b32 v82, 2, v82
    v_mad_i32_i24 v82, v6, s35, v82
    v_lshl_or_b32 v78, v78, 13, v82
    v_lshlrev_b32 v82, 2, v6
    ds_add_rtn_u32 v114, v82, v3
    v_mul_hi_u32_u24 v7, s34, v83
    v_lshlrev_b32 v83, 2, v83
    v_mad_i32_i24 v83, v7, s35, v83
    v_lshl_or_b32 v79, v79, 13, v83
    v_lshlrev_b32 v83, 2, v7
    ds_add_rtn_u32 v115, v83, v3
    s_mov_b64 exec, -1
p1_h3skip:
    s_waitcnt vmcnt(12)
    v_mul_hi_u32_u24 v4, s34, v30
    v_lshlrev_b32 v30, 2, v30
    v_mad_i32_i24 v30, v4, s35, v30
    v_lshl_or_b32 v26, v26, 13, v30
    v_lshlrev_b32 v30, 2, v4
    ds_add_rtn_u32 v92, v30, v3
    v_mul_hi_u32_u24 v5, s34, v31
    v_lshlrev_b32 v31, 2, v31
    v_mad_i32_i24 v31, v5, s35, v31
    v_lshl_or_b32 v27, v27, 13, v31
    v_lshlrev_b32 v31, 2, v5
    ds_add_rtn_u32 v93, v31, v3
    v_mul_hi_u32_u24 v6, s34, v32
    v_lshlrev_b32 v32, 2, v32
    v_mad_i32_i24 v32, v6, s35, v32
    v_lshl_or_b32 v28, v28, 13, v32
    v_lshlrev_b32 v32, 2, v6
    ds_add_rtn_u32 v94, v32, v3
    v_mul_hi_u32_u24 v7, s34, v33
    v_lshlrev_b32 v33, 2, v33
    v_mad_i32_i24 v33, v7, s35, v33
    v_lshl_or_b32 v29, v29, 13, v33
    v_lshlrev_b32 v33, 2, v7
    ds_add_rtn_u32 v95, v33, v3
    s_waitcnt vmcnt(9)
    v_mul_hi_u32_u24 v4, s34, v40
    v_lshlrev_b32 v40, 2, v40
    v_mad_i32_i24 v40, v4, s35, v40
    v_lshl_or_b32 v36, v36, 13, v40
    v_lshlrev_b32 v40, 2, v4
    ds_add_rtn_u32 v96, v40, v3
    v_mul_hi_u32_u24 v5, s34, v41
    v_lshlrev_b32 v41, 2, v41
    v_mad_i32_i24 v41, v5, s35, v41
    v_lshl_or_b32 v37, v37, 13, v41
    v_lshlrev_b32 v41, 2, v5
    ds_add_rtn_u32 v97, v41, v3
    v_mul_hi_u32_u24 v6, s34, v42
    v_lshlrev_b32 v42, 2, v42
    v_mad_i32_i24 v42, v6, s35, v42
    v_lshl_or_b32 v38, v38, 13, v42
    v_lshlrev_b32 v42, 2, v6
    ds_add_rtn_u32 v98, v42, v3
    v_mul_hi_u32_u24 v7, s34, v43
    v_lshlrev_b32 v43, 2, v43
    v_mad_i32_i24 v43, v7, s35, v43
    v_lshl_or_b32 v39, v39, 13, v43
    v_lshlrev_b32 v43, 2, v7
    ds_add_rtn_u32 v99, v43, v3
    s_waitcnt vmcnt(6)
    v_mul_hi_u32_u24 v4, s34, v50
    v_lshlrev_b32 v50, 2, v50
    v_mad_i32_i24 v50, v4, s35, v50
    v_lshl_or_b32 v46, v46, 13, v50
    v_lshlrev_b32 v50, 2, v4
    ds_add_rtn_u32 v100, v50, v3
    v_mul_hi_u32_u24 v5, s34, v51
    v_lshlrev_b32 v51, 2, v51
    v_mad_i32_i24 v51, v5, s35, v51
    v_lshl_or_b32 v47, v47, 13, v51
    v_lshlrev_b32 v51, 2, v5
    ds_add_rtn_u32 v101, v51, v3
    v_mul_hi_u32_u24 v6, s34, v52
    v_lshlrev_b32 v52, 2, v52
    v_mad_i32_i24 v52, v6, s35, v52
    v_lshl_or_b32 v48, v48, 13, v52
    v_lshlrev_b32 v52, 2, v6
    ds_add_rtn_u32 v102, v52, v3
    v_mul_hi_u32_u24 v7, s34, v53
    v_lshlrev_b32 v53, 2, v53
    v_mad_i32_i24 v53, v7, s35, v53
    v_lshl_or_b32 v49, v49, 13, v53
    v_lshlrev_b32 v53, 2, v7
    ds_add_rtn_u32 v103, v53, v3
    s_waitcnt vmcnt(3)
    v_mul_hi_u32_u24 v4, s34, v60
    v_lshlrev_b32 v60, 2, v60
    v_mad_i32_i24 v60, v4, s35, v60
    v_lshl_or_b32 v56, v56, 13, v60
    v_lshlrev_b32 v60, 2, v4
    ds_add_rtn_u32 v104, v60, v3
    v_mul_hi_u32_u24 v5, s34, v61
    v_lshlrev_b32 v61, 2, v61
    v_mad_i32_i24 v61, v5, s35, v61
    v_lshl_or_b32 v57, v57, 13, v61
    v_lshlrev_b32 v61, 2, v5
    ds_add_rtn_u32 v105, v61, v3
    v_mul_hi_u32_u24 v6, s34, v62
    v_lshlrev_b32 v62, 2, v62
    v_mad_i32_i24 v62, v6, s35, v62
    v_lshl_or_b32 v58, v58, 13, v62
    v_lshlrev_b32 v62, 2, v6
    ds_add_rtn_u32 v106, v62, v3
    v_mul_hi_u32_u24 v7, s34, v63
    v_lshlrev_b32 v63, 2, v63
    v_mad_i32_i24 v63, v7, s35, v63
    v_lshl_or_b32 v59, v59, 13, v63
    v_lshlrev_b32 v63, 2, v7
    ds_add_rtn_u32 v107, v63, v3
    s_waitcnt vmcnt(0)
    v_mul_hi_u32_u24 v4, s34, v70
    v_lshlrev_b32 v70, 2, v70
    v_mad_i32_i24 v70, v4, s35, v70
    v_lshl_or_b32 v66, v66, 13, v70
    v_lshlrev_b32 v70, 2, v4
    ds_add_rtn_u32 v108, v70, v3
    v_mul_hi_u32_u24 v5, s34, v71
    v_lshlrev_b32 v71, 2, v71
    v_mad_i32_i24 v71, v5, s35, v71
    v_lshl_or_b32 v67, v67, 13, v71
    v_lshlrev_b32 v71, 2, v5
    ds_add_rtn_u32 v109, v71, v3
    v_mul_hi_u32_u24 v6, s34, v72
    v_lshlrev_b32 v72, 2, v72
    v_mad_i32_i24 v72, v6, s35, v72
    v_lshl_or_b32 v68, v68, 13, v72
    v_lshlrev_b32 v72, 2, v6
    ds_add_rtn_u32 v110, v72, v3
    v_mul_hi_u32_u24 v7, s34, v73
    v_lshlrev_b32 v73, 2, v73
    v_mad_i32_i24 v73, v7, s35, v73
    v_lshl_or_b32 v69, v69, 13, v73
    v_lshlrev_b32 v73, 2, v7
    ds_add_rtn_u32 v111, v73, v3
    s_waitcnt lgkmcnt(0)
    s_barrier
    s_cmp_lg_u32 s3, 0
    s_cbranch_scc1 p1_scan_skip
    ds_read_b128 v[4:7], v1
    s_waitcnt lgkmcnt(0)
    v_add_u32 v5, v4, v5
    v_add_u32 v6, v5, v6
    v_add_u32 v7, v6, v7
    v_mov_b32 v8, v7
    s_nop 1
    v_add_u32_dpp v8, v8, v8 row_shr:1 row_mask:0xf bank_mask:0xf bound_ctrl:0
    s_nop 1
    v_add_u32_dpp v8, v8, v8 row_shr:2 row_mask:0xf bank_mask:0xf bound_ctrl:0
    s_nop 1
    v_add_u32_dpp v8, v8, v8 row_shr:4 row_mask:0xf bank_mask:0xf bound_ctrl:0
    s_nop 1
    v_add_u32_dpp v8, v8, v8 row_shr:8 row_mask:0xf bank_mask:0xf bound_ctrl:0
    s_nop 1
    v_add_u32_dpp v8, v8, v8 row_bcast:15 row_mask:0xa bank_mask:0xf
    s_nop 1
    v_add_u32_dpp v8, v8, v8 row_bcast:31 row_mask:0xc bank_mask:0xf
    v_sub_u32 v9, v8, v7
    v_add_u32 v10, v9, v4
    v_add_u32 v11, v9, v5
    v_add_u32 v15, v9, v6
    v_lshl_or_b32 v4, v10, 16, v9
    v_lshl_or_b32 v5, v11, 16, v10
    v_lshl_or_b32 v6, v15, 16, v11
    v_lshl_or_b32 v7, v8, 16, v15
    v_add_u32 v8, 512, v9
    v_add_u32 v9, 512, v10
    v_add_u32 v10, 512, v11
    v_add_u32 v11, 512, v15
    ds_write_b128 v1, v[8:11]
    s_lshl_b32 s36, s2, 10
    s_waitcnt lgkmcnt(0)
    s_barrier
    buffer_store_dwordx4 v[4:7], v1, s[24:27], s36 offen sc1
    s_nop 1
    s_branch p1_scan_done
p1_scan_skip:
    s_barrier
p1_scan_done:
    s_cmp_lg_u32 s3, 7
    s_cbranch_scc1 p1_notouch
    s_and_b32 s41, s41, 0xffff
    s_mov_b32 s42, 3200000
    s_mov_b32 s43, 0x00020000
    s_and_b32 s45, s45, 0xffff
    s_mov_b32 s46, 800000
    s_mov_b32 s47, 0x00020000
    v_and_b32 v86, 63, v0
    v_lshlrev_b32 v86, 7, v86
    s_mul_i32 s36, s2, 6272
    s_mul_i32 s37, s2, 1664
    s_mov_b32 exec_hi, 0x1ffff
    buffer_load_dword v87, v86, s[40:43], s36 offen
    s_mov_b64 exec, 0x1fff
    buffer_load_dword v87, v86, s[44:47], s37 offen
    s_mov_b64 exec, -1
p1_notouch:
    s_cmp_lg_u32 s3, 0
    s_cbranch_scc1 p1_b3skip
    s_mov_b32 exec_lo, 4294967295
    s_mov_b32 exec_hi, 2097151
    ds_read_b32 v80, v80
    ds_read_b32 v81, v81
    ds_read_b32 v82, v82
    ds_read_b32 v83, v83
    s_waitcnt lgkmcnt(0)
    v_add_lshl_u32 v112, v80, v112, 1
    v_and_b32 v4, 2, v112
    v_add_u32 v80, v112, v4
    v_mad_i32_i24 v112, v4, -2, v112
    ds_write_b32 v80, v76
    ds_write_b16 v112, v84 offset:4
    v_add_lshl_u32 v113, v81, v113, 1
    v_and_b32 v5, 2, v113
    v_add_u32 v81, v113, v5
    v_mad_i32_i24 v113, v5, -2, v113
    ds_write_b32 v81, v77
    ds_write_b16_d16_hi v113, v84 offset:4
    v_add_lshl_u32 v114, v82, v114, 1
    v_and_b32 v6, 2, v114
    v_add_u32 v82, v114, v6
    v_mad_i32_i24 v114, v6, -2, v114
    ds_write_b32 v82, v78
    ds_write_b16 v114, v85 offset:4
    v_add_lshl_u32 v115, v83, v115, 1
    v_and_b32 v7, 2, v115
    v_add_u32 v83, v115, v7
    v_mad_i32_i24 v115, v7, -2, v115
    ds_write_b32 v83, v79
    ds_write_b16_d16_hi v115, v85 offset:4
    s_mov_b64 exec, -1
p1_b3skip:
    ds_read_b32 v20, v20
    ds_read_b32 v21, v21
    ds_read_b32 v22, v22
    ds_read_b32 v23, v23
    ds_read_b32 v30, v30
    ds_read_b32 v31, v31
    ds_read_b32 v32, v32
    ds_read_b32 v33, v33
    ds_read_b32 v40, v40
    ds_read_b32 v41, v41
    ds_read_b32 v42, v42
    ds_read_b32 v43, v43
    s_waitcnt lgkmcnt(8)
    v_add_lshl_u32 v88, v20, v88, 1
    v_and_b32 v4, 2, v88
    v_add_u32 v20, v88, v4
    v_mad_i32_i24 v88, v4, -2, v88
    ds_write_b32 v20, v16
    ds_write_b16 v88, v24 offset:4
    v_add_lshl_u32 v89, v21, v89, 1
    v_and_b32 v5, 2, v89
    v_add_u32 v21, v89, v5
    v_mad_i32_i24 v89, v5, -2, v89
    ds_write_b32 v21, v17
    ds_write_b16_d16_hi v89, v24 offset:4
    v_add_lshl_u32 v90, v22, v90, 1
    v_and_b32 v6, 2, v90
    v_add_u32 v22, v90, v6
    v_mad_i32_i24 v90, v6, -2, v90
    ds_write_b32 v22, v18
    ds_write_b16 v90, v25 offset:4
    v_add_lshl_u32 v91, v23, v91, 1
    v_and_b32 v7, 2, v91
    v_add_u32 v23, v91, v7
    v_mad_i32_i24 v91, v7, -2, v91
    ds_write_b32 v23, v19
    ds_write_b16_d16_hi v91, v25 offset:4
    ds_read_b32 v50, v50
    ds_read_b32 v51, v51
    ds_read_b32 v52, v52
    ds_read_b32 v53, v53
    s_waitcnt lgkmcnt(12)
    v_add_lshl_u32 v92, v30, v92, 1
    v_and_b32 v4, 2, v92
    v_add_u32 v30, v92, v4
    v_mad_i32_i24 v92, v4, -2, v92
    ds_write_b32 v30, v26
    ds_write_b16 v92, v34 offset:4
    v_add_lshl_u32 v93, v31, v93, 1
    v_and_b32 v5, 2, v93
    v_add_u32 v31, v93, v5
    v_mad_i32_i24 v93, v5, -2, v93
    ds_write_b32 v31, v27
    ds_write_b16_d16_hi v93, v34 offset:4
    v_add_lshl_u32 v94, v32, v94, 1
    v_and_b32 v6, 2, v94
    v_add_u32 v32, v94, v6
    v_mad_i32_i24 v94, v6, -2, v94
    ds_write_b32 v32, v28
    ds_write_b16 v94, v35 offset:4
    v_add_lshl_u32 v95, v33, v95, 1
    v_and_b32 v7, 2, v95
    v_add_u32 v33, v95, v7
    v_mad_i32_i24 v95, v7, -2, v95
    ds_write_b32 v33, v29
    ds_write_b16_d16_hi v95, v35 offset:4
    ds_read_b32 v60, v60
    ds_read_b32 v61, v61
    ds_read_b32 v62, v62
    ds_read_b32 v63, v63
    s_waitcnt lgkmcnt(12)
    v_add_lshl_u32 v96, v40, v96, 1
    v_and_b32 v4, 2, v96
    v_add_u32 v40, v96, v4
    v_mad_i32_i24 v96, v4, -2, v96
    ds_write_b32 v40, v36
    ds_write_b16 v96, v44 offset:4
    v_add_lshl_u32 v97, v41, v97, 1
    v_and_b32 v5, 2, v97
    v_add_u32 v41, v97, v5
    v_mad_i32_i24 v97, v5, -2, v97
    ds_write_b32 v41, v37
    ds_write_b16_d16_hi v97, v44 offset:4
    v_add_lshl_u32 v98, v42, v98, 1
    v_and_b32 v6, 2, v98
    v_add_u32 v42, v98, v6
    v_mad_i32_i24 v98, v6, -2, v98
    ds_write_b32 v42, v38
    ds_write_b16 v98, v45 offset:4
    v_add_lshl_u32 v99, v43, v99, 1
    v_and_b32 v7, 2, v99
    v_add_u32 v43, v99, v7
    v_mad_i32_i24 v99, v7, -2, v99
    ds_write_b32 v43, v39
    ds_write_b16_d16_hi v99, v45 offset:4
    ds_read_b32 v70, v70
    ds_read_b32 v71, v71
    ds_read_b32 v72, v72
    ds_read_b32 v73, v73
    s_waitcnt lgkmcnt(12)
    v_add_lshl_u32 v100, v50, v100, 1
    v_and_b32 v4, 2, v100
    v_add_u32 v50, v100, v4
    v_mad_i32_i24 v100, v4, -2, v100
    ds_write_b32 v50, v46
    ds_write_b16 v100, v54 offset:4
    v_add_lshl_u32 v101, v51, v101, 1
    v_and_b32 v5, 2, v101
    v_add_u32 v51, v101, v5
    v_mad_i32_i24 v101, v5, -2, v101
    ds_write_b32 v51, v47
    ds_write_b16_d16_hi v101, v54 offset:4
    v_add_lshl_u32 v102, v52, v102, 1
    v_and_b32 v6, 2, v102
    v_add_u32 v52, v102, v6
    v_mad_i32_i24 v102, v6, -2, v102
    ds_write_b32 v52, v48
    ds_write_b16 v102, v55 offset:4
    v_add_lshl_u32 v103, v53, v103, 1
    v_and_b32 v7, 2, v103
    v_add_u32 v53, v103, v7
    v_mad_i32_i24 v103, v7, -2, v103
    ds_write_b32 v53, v49
    ds_write_b16_d16_hi v103, v55 offset:4
    s_waitcnt lgkmcnt(8)
    v_add_lshl_u32 v104, v60, v104, 1
    v_and_b32 v4, 2, v104
    v_add_u32 v60, v104, v4
    v_mad_i32_i24 v104, v4, -2, v104
    ds_write_b32 v60, v56
    ds_write_b16 v104, v64 offset:4
    v_add_lshl_u32 v105, v61, v105, 1
    v_and_b32 v5, 2, v105
    v_add_u32 v61, v105, v5
    v_mad_i32_i24 v105, v5, -2, v105
    ds_write_b32 v61, v57
    ds_write_b16_d16_hi v105, v64 offset:4
    v_add_lshl_u32 v106, v62, v106, 1
    v_and_b32 v6, 2, v106
    v_add_u32 v62, v106, v6
    v_mad_i32_i24 v106, v6, -2, v106
    ds_write_b32 v62, v58
    ds_write_b16 v106, v65 offset:4
    v_add_lshl_u32 v107, v63, v107, 1
    v_and_b32 v7, 2, v107
    v_add_u32 v63, v107, v7
    v_mad_i32_i24 v107, v7, -2, v107
    ds_write_b32 v63, v59
    ds_write_b16_d16_hi v107, v65 offset:4
    s_waitcnt lgkmcnt(8)
    v_add_lshl_u32 v108, v70, v108, 1
    v_and_b32 v4, 2, v108
    v_add_u32 v70, v108, v4
    v_mad_i32_i24 v108, v4, -2, v108
    ds_write_b32 v70, v66
    ds_write_b16 v108, v74 offset:4
    v_add_lshl_u32 v109, v71, v109, 1
    v_and_b32 v5, 2, v109
    v_add_u32 v71, v109, v5
    v_mad_i32_i24 v109, v5, -2, v109
    ds_write_b32 v71, v67
    ds_write_b16_d16_hi v109, v74 offset:4
    v_add_lshl_u32 v110, v72, v110, 1
    v_and_b32 v6, 2, v110
    v_add_u32 v72, v110, v6
    v_mad_i32_i24 v110, v6, -2, v110
    ds_write_b32 v72, v68
    ds_write_b16 v110, v75 offset:4
    v_add_lshl_u32 v111, v73, v111, 1
    v_and_b32 v7, 2, v111
    v_add_u32 v73, v111, v7
    v_mad_i32_i24 v111, v7, -2, v111
    ds_write_b32 v73, v69
    ds_write_b16_d16_hi v111, v75 offset:4
    s_waitcnt lgkmcnt(0)
    s_barrier
    s_setprio 0
    ds_read_b128 v[16:19], v12 offset:0
    ds_read_b128 v[20:23], v12 offset:8192
    ds_read_b128 v[24:27], v12 offset:16384
    ds_read_b128 v[28:31], v12 offset:24576
    ds_read_b128 v[32:35], v12 offset:32768
    ds_read_b128 v[36:39], v12 offset:40960
    ds_read_b128 v[40:43], v12 offset:49152
    ds_read_b128 v[44:47], v12 offset:57344
    ds_read_b128 v[48:51], v13 offset:0
    ds_read_b128 v[52:55], v13 offset:8192
    s_mul_i32 s36, s2, 75008
    s_waitcnt lgkmcnt(9)
    buffer_store_dwordx4 v[16:19], v1, s[20:23], s36 offen sc1
    s_add_u32 s36, s36, 8192
    s_waitcnt lgkmcnt(8)
    buffer_store_dwordx4 v[20:23], v1, s[20:23], s36 offen sc1
    s_add_u32 s36, s36, 8192
    s_waitcnt lgkmcnt(7)
    buffer_store_dwordx4 v[24:27], v1, s[20:23], s36 offen sc1
    s_add_u32 s36, s36, 8192
    s_waitcnt lgkmcnt(6)
    buffer_store_dwordx4 v[28:31], v1, s[20:23], s36 offen sc1
    s_add_u32 s36, s36, 8192
    s_waitcnt lgkmcnt(5)
    buffer_store_dwordx4 v[32:35], v1, s[20:23], s36 offen sc1
    s_add_u32 s36, s36, 8192
    s_waitcnt lgkmcnt(4)
    buffer_store_dwordx4 v[36:39], v1, s[20:23], s36 offen sc1
    s_add_u32 s36, s36, 8192
    s_waitcnt lgkmcnt(3)
    buffer_store_dwordx4 v[40:43], v1, s[20:23], s36 offen sc1
    s_add_u32 s36, s36, 8192
    s_waitcnt lgkmcnt(2)
    buffer_store_dwordx4 v[44:47], v1, s[20:23], s36 offen sc1
    s_add_u32 s36, s36, 8192
    s_waitcnt lgkmcnt(1)
    buffer_store_dwordx4 v[48:51], v1, s[20:23], s36 offen sc1
    s_add_u32 s36, s36, 8192
    s_waitcnt lgkmcnt(0)
    buffer_store_dwordx4 v[52:55], v14, s[20:23], s36 offen sc1
    s_add_u32 s36, s36, 8192
p1_done:
    s_endpgm
.section .rodata,"a"
.p2align 6
.amdhsa_kernel part_kernel
  .amdhsa_next_free_vgpr 116
  .amdhsa_next_free_sgpr 48
  .amdhsa_accum_offset 116
  .amdhsa_group_segment_fixed_size 0
  .amdhsa_kernarg_size 112
  .amdhsa_user_sgpr_count 2
  .amdhsa_user_sgpr_kernarg_segment_ptr 1
  .amdhsa_system_sgpr_workgroup_id_x 1
  .amdhsa_float_denorm_mode_32 3
.end_amdhsa_kernel
.text

.globl acc_kernel
.p2align 8
.type acc_kernel,@function
acc_kernel:
    s_cmp_ge_u32 s2, 256
    s_cbranch_scc1 p2_done
    s_load_dwordx2 s[4:5], s[0:1], 0
    v_readfirstlane_b32 s3, v0
    s_lshr_b32 s3, s3, 6
    s_and_b32 s27, s2, 7
    s_lshl_b32 s27, s27, 5
    s_lshr_b32 s26, s2, 3
    s_add_u32 s27, s27, s26
    s_mul_i32 s25, s27, 1563
    s_lshl_b32 s24, s27, 2
    s_and_b32 s35, s26, 0
    s_mul_i32 s35, s35, 416
    s_lshr_b32 s35, s35, 1
    s_mov_b32 s16, 0
    s_mov_b64 s[18:19], -1
    s_mov_b64 s[20:21], -1
    s_movk_i32 s34, 776
    s_cmp_lt_u32 s3, 8
    s_cbranch_scc1 a_batch
    v_mov_b32 v44, 0
    v_mov_b32 v45, 0
    v_mov_b32 v46, 0
    v_mov_b32 v47, 0
    v_mov_b32 v48, 0
    v_mov_b32 v49, 0
    v_mov_b32 v50, 0
    v_mov_b32 v51, 0
    v_mov_b32 v52, 0
    v_mov_b32 v53, 0
    v_mov_b32 v54, 0
    v_mov_b32 v55, 0
    v_mov_b32 v56, 0
    v_mov_b32 v57, 0
    v_mov_b32 v58, 0
    v_mov_b32 v59, 0
    v_mov_b32 v60, 0
    v_mov_b32 v61, 0
    v_mov_b32 v62, 0
    v_mov_b32 v63, 0
    v_mov_b32 v64, 0
    v_mov_b32 v65, 0
    v_mov_b32 v66, 0
    v_mov_b32 v67, 0
    v_mov_b32 v68, 0
    v_mov_b32 v69, 0
    v_mov_b32 v70, 0
    v_mov_b32 v71, 0
    v_mov_b32 v72, 0
    v_mov_b32 v73, 0
    v_mov_b32 v74, 0
    v_mov_b32 v75, 0
    v_mov_b32 v76, 0
    v_mov_b32 v77, 0
    v_mov_b32 v78, 0
    v_mov_b32 v79, 0
    v_mov_b32 v80, 0
    v_mov_b32 v81, 0
    v_mov_b32 v82, 0
    v_mov_b32 v83, 0
    v_mov_b32 v84, 0
    v_mov_b32 v85, 0
    v_mov_b32 v86, 0
    v_mov_b32 v87, 0
    v_mov_b32 v88, 0
    v_mov_b32 v89, 0
    v_mov_b32 v90, 0
    v_mov_b32 v91, 0
a_batch:
    s_load_dwordx2 s[8:9], s[0:1], 104
    s_movk_i32 s34, 776
    s_setprio 3
    v_lshlrev_b32 v30, 2, v0
    v_mov_b32 v31, 0
    v_cmp_gt_u32 vcc, 256, v0
    s_mov_b64 exec, vcc
    ds_write_b32 v30, v31 offset:0
    s_mov_b64 exec, -1
    v_and_b32 v32, 31, v0
    v_lshrrev_b32 v33, 5, v0
    v_lshl_add_u32 v33, v33, 4, v32
    v_lshlrev_b32 v28, 10, v33
    v_cmp_gt_u32 vcc, 16, v32
    v_mul_u32_u24 v1, 6, v32
    v_add_u32 v2, 3, v1
    v_cndmask_b32 v28, 2.0, v28, vcc
    v_lshlrev_b32 v27, 1, v1
    v_and_b32 v23, 32, v0
    v_lshlrev_b32 v23, 2, v23
    v_mov_b32 v3, 2
    s_mov_b32 s26, 75008
    v_mul_lo_u32 v7, v33, s26
    s_waitcnt lgkmcnt(0)
    s_add_u32 s8, s8, 0
    s_addc_u32 s9, s9, 0
    s_add_u32 s12, s8, 41943040
    s_addc_u32 s13, s9, 0
    s_and_b32 s13, s13, 0xffff
    s_mov_b32 s14, 524288
    s_mov_b32 s15, 0x00020000
    buffer_load_dword v29, v28, s[12:15], s24 offen
    s_and_b32 s9, s9, 0xffff
    s_mov_b32 s10, 38404096
    s_mov_b32 s11, 0x00020000
    s_and_b32 s5, s5, 0xffff
    s_or_b32 s5, s5, 0x80000
    s_mov_b32 s6, 400000
    s_mov_b32 s7, 0x00020000
    s_mov_b32 s17, 0
    s_mov_b32 s22, -1
    s_mov_b32 s33, 0
    s_barrier
    s_waitcnt vmcnt(0)
    v_and_b32 v30, 0xffff, v29
    v_lshrrev_b32 v31, 16, v29
    v_and_b32 v32, 1, v29
    v_mul_u32_u24 v32, 3, v32
    v_sub_u32 v30, v30, v32
    v_sub_u32 v31, v31, v30
    v_lshl_add_u32 v7, v30, 1, v7
    v_lshl_or_b32 v11, v32, 16, v31
    v_cmp_lt_u32 vcc, v32, v31
    s_or_b32 s32, vcc_lo, vcc_hi
    s_mov_b32 s27, s16
a_replay:
    s_cmp_eq_u32 s27, 0
    s_cbranch_scc1 a_replay_done
    s_cmp_lg_u32 s32, 0
    s_cbranch_scc1 a_rp_have
    s_cmp_lg_u32 s22, -1
    s_cbranch_scc1 a_rp_none
    v_and_b32 v28, 0xffff, v11
    v_subrev_u32 v28, 192, v28
    v_max_i32 v11, 0, v28
    v_add_u32 v7, 384, v7
    v_cmp_lt_u32 vcc, 0, v11
    s_or_b32 s32, vcc_lo, vcc_hi
    s_cbranch_scc1 a_rp_have
    s_mov_b32 s22, 6
    s_branch a_rp_none
a_rp_have:
    s_ff1_i32_b32 s26, s32
    s_bitset0_b32 s32, s26
a_rp_none:
    s_sub_u32 s27, s27, 1
    s_branch a_replay
a_replay_done:
    s_mov_b64 s[36:37], 0
    s_mov_b64 s[38:39], 0
    s_mov_b64 s[40:41], 0
    s_mov_b64 s[42:43], 0
    s_mov_b64 s[44:45], 0
    s_mov_b64 s[46:47], 0
    s_mov_b64 s[48:49], 0
    s_mov_b64 s[50:51], 0
    s_mov_b64 s[52:53], 0
    s_mov_b64 s[54:55], 0
    s_mov_b64 s[56:57], 0
    s_mov_b64 s[58:59], 0
    s_cmp_lg_u32 s32, 0
    s_cbranch_scc1 a_p0_have
    s_cmp_lg_u32 s22, -1
    s_cbranch_scc1 a_p0_none
    v_and_b32 v28, 0xffff, v11
    v_subrev_u32 v28, 192, v28
    v_max_i32 v11, 0, v28
    v_add_u32 v7, 384, v7
    v_cmp_lt_u32 vcc, 0, v11
    s_or_b32 s32, vcc_lo, vcc_hi
    s_cbranch_scc1 a_p0_have
    s_mov_b32 s22, 6
    s_branch a_p0_none
a_p0_have:
    s_ff1_i32_b32 s26, s32
    s_bitset0_b32 s32, s26
    s_lshl_b32 s26, s26, 2
    v_add_u32 v28, s26, v23
    ds_bpermute_b32 v15, v28, v7
    ds_bpermute_b32 v19, v28, v11
a_p0_none:
    s_cmp_lg_u32 s22, -1
    s_cbranch_scc1 a_pro_done
    s_waitcnt lgkmcnt(0)
    v_add_u32 v29, v15, v27
    v_cmp_lt_u32_sdwa vcc, v1, v19 src0_sel:DWORD src1_sel:WORD_0
    v_cmp_ge_u32_sdwa s[36:37], v1, v19 src0_sel:DWORD src1_sel:WORD_1
    v_cmp_lt_u32_sdwa s[38:39], v2, v19 src0_sel:DWORD src1_sel:WORD_0
    s_or_b64 exec, vcc, 1
    buffer_load_dwordx3 v[4:6], v29, s[8:11], 0 offen
    s_mov_b64 exec, -1
    s_and_b64 s[36:37], s[36:37], vcc
    s_cmp_lg_u32 s32, 0
    s_cbranch_scc1 a_pi0_have
    s_cmp_lg_u32 s22, -1
    s_cbranch_scc1 a_pi0_none
    v_and_b32 v28, 0xffff, v11
    v_subrev_u32 v28, 192, v28
    v_max_i32 v11, 0, v28
    v_add_u32 v7, 384, v7
    v_cmp_lt_u32 vcc, 0, v11
    s_or_b32 s32, vcc_lo, vcc_hi
    s_cbranch_scc1 a_pi0_have
    s_mov_b32 s22, 6
    s_branch a_pi0_none
a_pi0_have:
    s_ff1_i32_b32 s26, s32
    s_bitset0_b32 s32, s26
    s_lshl_b32 s26, s26, 2
    v_add_u32 v28, s26, v23
    ds_bpermute_b32 v15, v28, v7
    ds_bpermute_b32 v19, v28, v11
a_pi0_none:
    s_and_b64 s[36:37], s[36:37], s[18:19]
    s_and_b64 s[38:39], s[38:39], s[20:21]
    s_mov_b64 s[18:19], -1
    s_mov_b64 s[20:21], -1
    s_cmp_lg_u32 s22, -1
    s_cbranch_scc1 a_pro_done
    s_waitcnt lgkmcnt(0)
    v_add_u32 v29, v15, v27
    v_cmp_lt_u32_sdwa vcc, v1, v19 src0_sel:DWORD src1_sel:WORD_0
    v_cmp_ge_u32_sdwa s[40:41], v1, v19 src0_sel:DWORD src1_sel:WORD_1
    v_cmp_lt_u32_sdwa s[42:43], v2, v19 src0_sel:DWORD src1_sel:WORD_0
    s_or_b64 exec, vcc, 1
    buffer_load_dwordx3 v[8:10], v29, s[8:11], 0 offen
    s_mov_b64 exec, -1
    s_and_b64 s[40:41], s[40:41], vcc
    s_cmp_lg_u32 s32, 0
    s_cbranch_scc1 a_pi1_have
    s_cmp_lg_u32 s22, -1
    s_cbranch_scc1 a_pi1_none
    v_and_b32 v28, 0xffff, v11
    v_subrev_u32 v28, 192, v28
    v_max_i32 v11, 0, v28
    v_add_u32 v7, 384, v7
    v_cmp_lt_u32 vcc, 0, v11
    s_or_b32 s32, vcc_lo, vcc_hi
    s_cbranch_scc1 a_pi1_have
    s_mov_b32 s22, 6
    s_branch a_pi1_none
a_pi1_have:
    s_ff1_i32_b32 s26, s32
    s_bitset0_b32 s32, s26
    s_lshl_b32 s26, s26, 2
    v_add_u32 v28, s26, v23
    ds_bpermute_b32 v15, v28, v7
    ds_bpermute_b32 v19, v28, v11
a_pi1_none:
    s_cmp_lg_u32 s22, -1
    s_cbranch_scc1 a_pro_done
    s_waitcnt lgkmcnt(0)
    v_add_u32 v29, v15, v27
    v_cmp_lt_u32_sdwa vcc, v1, v19 src0_sel:DWORD src1_sel:WORD_0
    v_cmp_ge_u32_sdwa s[44:45], v1, v19 src0_sel:DWORD src1_sel:WORD_1
    v_cmp_lt_u32_sdwa s[46:47], v2, v19 src0_sel:DWORD src1_sel:WORD_0
    s_or_b64 exec, vcc, 1
    buffer_load_dwordx3 v[12:14], v29, s[8:11], 0 offen
    s_mov_b64 exec, -1
    s_and_b64 s[44:45], s[44:45], vcc
    s_cmp_lg_u32 s32, 0
    s_cbranch_scc1 a_pi2_have
    s_cmp_lg_u32 s22, -1
    s_cbranch_scc1 a_pi2_none
    v_and_b32 v28, 0xffff, v11
    v_subrev_u32 v28, 192, v28
    v_max_i32 v11, 0, v28
    v_add_u32 v7, 384, v7
    v_cmp_lt_u32 vcc, 0, v11
    s_or_b32 s32, vcc_lo, vcc_hi
    s_cbranch_scc1 a_pi2_have
    s_mov_b32 s22, 6
    s_branch a_pi2_none
a_pi2_have:
    s_ff1_i32_b32 s26, s32
    s_bitset0_b32 s32, s26
    s_lshl_b32 s26, s26, 2
    v_add_u32 v28, s26, v23
    ds_bpermute_b32 v15, v28, v7
    ds_bpermute_b32 v19, v28, v11
a_pi2_none:
    s_cmp_lg_u32 s22, -1
    s_cbranch_scc1 a_pro_done
    s_waitcnt lgkmcnt(0)
    v_add_u32 v29, v15, v27
    v_cmp_lt_u32_sdwa vcc, v1, v19 src0_sel:DWORD src1_sel:WORD_0
    v_cmp_ge_u32_sdwa s[48:49], v1, v19 src0_sel:DWORD src1_sel:WORD_1
    v_cmp_lt_u32_sdwa s[50:51], v2, v19 src0_sel:DWORD src1_sel:WORD_0
    s_or_b64 exec, vcc, 1
    buffer_load_dwordx3 v[16:18], v29, s[8:11], 0 offen
    s_mov_b64 exec, -1
    s_and_b64 s[48:49], s[48:49], vcc
    s_cmp_lg_u32 s32, 0
    s_cbranch_scc1 a_pi3_have
    s_cmp_lg_u32 s22, -1
    s_cbranch_scc1 a_pi3_none
    v_and_b32 v28, 0xffff, v11
    v_subrev_u32 v28, 192, v28
    v_max_i32 v11, 0, v28
    v_add_u32 v7, 384, v7
    v_cmp_lt_u32 vcc, 0, v11
    s_or_b32 s32, vcc_lo, vcc_hi
    s_cbranch_scc1 a_pi3_have
    s_mov_b32 s22, 6
    s_branch a_pi3_none
a_pi3_have:
    s_ff1_i32_b32 s26, s32
    s_bitset0_b32 s32, s26
    s_lshl_b32 s26, s26, 2
    v_add_u32 v28, s26, v23
    ds_bpermute_b32 v15, v28, v7
    ds_bpermute_b32 v19, v28, v11
a_pi3_none:
    s_cmp_lg_u32 s22, -1
    s_cbranch_scc1 a_pro_done
    s_waitcnt lgkmcnt(0)
    v_add_u32 v29, v15, v27
    v_cmp_lt_u32_sdwa vcc, v1, v19 src0_sel:DWORD src1_sel:WORD_0
    v_cmp_ge_u32_sdwa s[52:53], v1, v19 src0_sel:DWORD src1_sel:WORD_1
    v_cmp_lt_u32_sdwa s[54:55], v2, v19 src0_sel:DWORD src1_sel:WORD_0
    s_or_b64 exec, vcc, 1
    buffer_load_dwordx3 v[20:22], v29, s[8:11], 0 offen
    s_mov_b64 exec, -1
    s_and_b64 s[52:53], s[52:53], vcc
    s_cmp_lg_u32 s32, 0
    s_cbranch_scc1 a_pi4_have
    s_cmp_lg_u32 s22, -1
    s_cbranch_scc1 a_pi4_none
    v_and_b32 v28, 0xffff, v11
    v_subrev_u32 v28, 192, v28
    v_max_i32 v11, 0, v28
    v_add_u32 v7, 384, v7
    v_cmp_lt_u32 vcc, 0, v11
    s_or_b32 s32, vcc_lo, vcc_hi
    s_cbranch_scc1 a_pi4_have
    s_mov_b32 s22, 6
    s_branch a_pi4_none
a_pi4_have:
    s_ff1_i32_b32 s26, s32
    s_bitset0_b32 s32, s26
    s_lshl_b32 s26, s26, 2
    v_add_u32 v28, s26, v23
    ds_bpermute_b32 v15, v28, v7
    ds_bpermute_b32 v19, v28, v11
a_pi4_none:
a_pro_done:
a_loop:
    s_cmp_lt_u32 s17, 3
    s_cbranch_scc1 a_pr0
    s_setprio 2
    s_cmp_lt_u32 s17, 6
    s_cbranch_scc1 a_pr0
    s_setprio 1
    s_cmp_lt_u32 s17, 9
    s_cbranch_scc1 a_pr0
    s_setprio 0
a_pr0:
    s_cmp_lg_u32 s22, -1
    s_cbranch_scc1 a_cd0
    s_waitcnt lgkmcnt(0)
    v_add_u32 v29, v15, v27
    v_cmp_lt_u32_sdwa vcc, v1, v19 src0_sel:DWORD src1_sel:WORD_0
    v_cmp_ge_u32_sdwa s[56:57], v1, v19 src0_sel:DWORD src1_sel:WORD_1
    v_cmp_lt_u32_sdwa s[58:59], v2, v19 src0_sel:DWORD src1_sel:WORD_0
    s_or_b64 exec, vcc, 1
    buffer_load_dwordx3 v[24:26], v29, s[8:11], 0 offen
    s_mov_b64 exec, -1
    s_and_b64 s[56:57], s[56:57], vcc
    s_cmp_lg_u32 s32, 0
    s_cbranch_scc1 a_li0_have
    s_cmp_lg_u32 s22, -1
    s_cbranch_scc1 a_li0_none
    v_and_b32 v28, 0xffff, v11
    v_subrev_u32 v28, 192, v28
    v_max_i32 v11, 0, v28
    v_add_u32 v7, 384, v7
    v_cmp_lt_u32 vcc, 0, v11
    s_or_b32 s32, vcc_lo, vcc_hi
    s_cbranch_scc1 a_li0_have
    s_mov_b32 s22, 6
    s_branch a_li0_none
a_li0_have:
    s_ff1_i32_b32 s26, s32
    s_bitset0_b32 s32, s26
    s_lshl_b32 s26, s26, 2
    v_add_u32 v28, s26, v23
    ds_bpermute_b32 v15, v28, v7
    ds_bpermute_b32 v19, v28, v11
a_li0_none:
    s_waitcnt vmcnt(5)
    s_branch a_go0
a_cd0:
    s_sub_u32 s22, s22, 1
    s_cmp_eq_u32 s22, 0
    s_cbranch_scc1 a_end
    s_mov_b64 s[56:57], 0
    s_mov_b64 s[58:59], 0
    s_waitcnt vmcnt(0)
a_go0:
    v_lshlrev_b32_sdwa v36, 2, v4 dst_sel:DWORD dst_unused:UNUSED_PAD src0_sel:DWORD src1_sel:BYTE_3
    v_lshlrev_b32_sdwa v37, 2, v6 dst_sel:DWORD dst_unused:UNUSED_PAD src0_sel:DWORD src1_sel:BYTE_3
    s_mov_b64 exec, s[36:37]
    ds_add_rtn_u32 v34, v36, v3 offset:0
    s_mov_b64 exec, s[38:39]
    ds_add_rtn_u32 v35, v37, v3 offset:0
    s_mov_b64 exec, -1
    v_mul_u32_u24_sdwa v32, s34, v4 dst_sel:DWORD dst_unused:UNUSED_PAD src0_sel:DWORD src1_sel:BYTE_3
    v_mul_u32_u24_sdwa v33, s34, v6 dst_sel:DWORD dst_unused:UNUSED_PAD src0_sel:DWORD src1_sel:BYTE_3
    s_waitcnt lgkmcnt(0)
    v_cmp_lt_u32 vcc, 0xff, v34
    s_and_b64 s[28:29], vcc, s[36:37]
    v_cmp_lt_u32 vcc, 0xff, v35
    s_and_b64 s[30:31], vcc, s[38:39]
    s_or_b64 vcc, s[28:29], s[30:31]
    s_cbranch_scc0 a_noovf0
    v_mov_b32 v36, 0
    s_mov_b64 exec, s[28:29]
    ds_add_rtn_u32 v34, v36, v3 offset:1008
    s_mov_b64 exec, s[30:31]
    ds_add_rtn_u32 v35, v36, v3 offset:1008
    s_waitcnt lgkmcnt(0)
    v_lshrrev_b32 v33, 8, v35
    v_cmp_le_u32 vcc, 13, v33
    v_add_u32 v33, 196, v33
    v_mul_u32_u24 v33, s34, v33
    v_and_b32 v35, 0xff, v35
    s_mov_b64 s[30:31], vcc
    s_mov_b64 exec, s[28:29]
    v_lshrrev_b32 v32, 8, v34
    v_cmp_le_u32 vcc, 13, v32
    v_add_u32 v32, 196, v32
    v_mul_u32_u24 v32, s34, v32
    v_and_b32 v34, 0xff, v34
    s_mov_b64 s[28:29], vcc
    s_mov_b64 exec, -1
    s_or_b64 vcc, s[28:29], s[30:31]
    s_cbranch_scc0 a_noovf0
    s_mov_b64 s[18:19], s[28:29]
    s_mov_b64 s[20:21], s[30:31]
    s_andn2_b64 s[36:37], s[36:37], s[28:29]
    s_andn2_b64 s[38:39], s[38:39], s[30:31]
    s_mov_b32 s33, 1
a_noovf0:
    v_lshl_add_u32 v36, v34, 1, v32
    v_lshl_add_u32 v37, v35, 1, v33
    v_add_u32 v34, v34, v32
    v_add_u32 v35, v35, v33
    s_mov_b64 exec, s[36:37]
    ds_write_b32 v36, v4 offset:1024
    ds_write_b16 v34, v5 offset:1536
    s_mov_b64 exec, s[38:39]
    ds_write_b32 v37, v6 offset:1024
    ds_write_b16_d16_hi v35, v5 offset:1536
    s_mov_b64 exec, -1
    s_cmp_lg_u32 s33, 0
    s_cbranch_scc1 a_stop
    s_add_u32 s17, s17, 1
    s_cmp_lt_u32 s17, 3
    s_cbranch_scc1 a_pr1
    s_setprio 2
    s_cmp_lt_u32 s17, 6
    s_cbranch_scc1 a_pr1
    s_setprio 1
    s_cmp_lt_u32 s17, 9
    s_cbranch_scc1 a_pr1
    s_setprio 0
a_pr1:
    s_cmp_lg_u32 s22, -1
    s_cbranch_scc1 a_cd1
    s_waitcnt lgkmcnt(0)
    v_add_u32 v29, v15, v27
    v_cmp_lt_u32_sdwa vcc, v1, v19 src0_sel:DWORD src1_sel:WORD_0
    v_cmp_ge_u32_sdwa s[36:37], v1, v19 src0_sel:DWORD src1_sel:WORD_1
    v_cmp_lt_u32_sdwa s[38:39], v2, v19 src0_sel:DWORD src1_sel:WORD_0
    s_or_b64 exec, vcc, 1
    buffer_load_dwordx3 v[4:6], v29, s[8:11], 0 offen
    s_mov_b64 exec, -1
    s_and_b64 s[36:37], s[36:37], vcc
    s_cmp_lg_u32 s32, 0
    s_cbranch_scc1 a_li1_have
    s_cmp_lg_u32 s22, -1
    s_cbranch_scc1 a_li1_none
    v_and_b32 v28, 0xffff, v11
    v_subrev_u32 v28, 192, v28
    v_max_i32 v11, 0, v28
    v_add_u32 v7, 384, v7
    v_cmp_lt_u32 vcc, 0, v11
    s_or_b32 s32, vcc_lo, vcc_hi
    s_cbranch_scc1 a_li1_have
    s_mov_b32 s22, 6
    s_branch a_li1_none
a_li1_have:
    s_ff1_i32_b32 s26, s32
    s_bitset0_b32 s32, s26
    s_lshl_b32 s26, s26, 2
    v_add_u32 v28, s26, v23
    ds_bpermute_b32 v15, v28, v7
    ds_bpermute_b32 v19, v28, v11
a_li1_none:
    s_waitcnt vmcnt(5)
    s_branch a_go1
a_cd1:
    s_sub_u32 s22, s22, 1
    s_cmp_eq_u32 s22, 0
    s_cbranch_scc1 a_end
    s_mov_b64 s[36:37], 0
    s_mov_b64 s[38:39], 0
    s_waitcnt vmcnt(0)
a_go1:
    v_lshlrev_b32_sdwa v36, 2, v8 dst_sel:DWORD dst_unused:UNUSED_PAD src0_sel:DWORD src1_sel:BYTE_3
    v_lshlrev_b32_sdwa v37, 2, v10 dst_sel:DWORD dst_unused:UNUSED_PAD src0_sel:DWORD src1_sel:BYTE_3
    s_mov_b64 exec, s[40:41]
    ds_add_rtn_u32 v34, v36, v3 offset:0
    s_mov_b64 exec, s[42:43]
    ds_add_rtn_u32 v35, v37, v3 offset:0
    s_mov_b64 exec, -1
    v_mul_u32_u24_sdwa v32, s34, v8 dst_sel:DWORD dst_unused:UNUSED_PAD src0_sel:DWORD src1_sel:BYTE_3
    v_mul_u32_u24_sdwa v33, s34, v10 dst_sel:DWORD dst_unused:UNUSED_PAD src0_sel:DWORD src1_sel:BYTE_3
    s_waitcnt lgkmcnt(0)
    v_cmp_lt_u32 vcc, 0xff, v34
    s_and_b64 s[28:29], vcc, s[40:41]
    v_cmp_lt_u32 vcc, 0xff, v35
    s_and_b64 s[30:31], vcc, s[42:43]
    s_or_b64 vcc, s[28:29], s[30:31]
    s_cbranch_scc0 a_noovf1
    v_mov_b32 v36, 0
    s_mov_b64 exec, s[28:29]
    ds_add_rtn_u32 v34, v36, v3 offset:1008
    s_mov_b64 exec, s[30:31]
    ds_add_rtn_u32 v35, v36, v3 offset:1008
    s_waitcnt lgkmcnt(0)
    v_lshrrev_b32 v33, 8, v35
    v_cmp_le_u32 vcc, 13, v33
    v_add_u32 v33, 196, v33
    v_mul_u32_u24 v33, s34, v33
    v_and_b32 v35, 0xff, v35
    s_mov_b64 s[30:31], vcc
    s_mov_b64 exec, s[28:29]
    v_lshrrev_b32 v32, 8, v34
    v_cmp_le_u32 vcc, 13, v32
    v_add_u32 v32, 196, v32
    v_mul_u32_u24 v32, s34, v32
    v_and_b32 v34, 0xff, v34
    s_mov_b64 s[28:29], vcc
    s_mov_b64 exec, -1
    s_or_b64 vcc, s[28:29], s[30:31]
    s_cbranch_scc0 a_noovf1
    s_mov_b64 s[18:19], s[28:29]
    s_mov_b64 s[20:21], s[30:31]
    s_andn2_b64 s[40:41], s[40:41], s[28:29]
    s_andn2_b64 s[42:43], s[42:43], s[30:31]
    s_mov_b32 s33, 1
a_noovf1:
    v_lshl_add_u32 v36, v34, 1, v32
    v_lshl_add_u32 v37, v35, 1, v33
    v_add_u32 v34, v34, v32
    v_add_u32 v35, v35, v33
    s_mov_b64 exec, s[40:41]
    ds_write_b32 v36, v8 offset:1024
    ds_write_b16 v34, v9 offset:1536
    s_mov_b64 exec, s[42:43]
    ds_write_b32 v37, v10 offset:1024
    ds_write_b16_d16_hi v35, v9 offset:1536
    s_mov_b64 exec, -1
    s_cmp_lg_u32 s33, 0
    s_cbranch_scc1 a_stop
    s_add_u32 s17, s17, 1
    s_cmp_lt_u32 s17, 3
    s_cbranch_scc1 a_pr2
    s_setprio 2
    s_cmp_lt_u32 s17, 6
    s_cbranch_scc1 a_pr2
    s_setprio 1
    s_cmp_lt_u32 s17, 9
    s_cbranch_scc1 a_pr2
    s_setprio 0
a_pr2:
    s_cmp_lg_u32 s22, -1
    s_cbranch_scc1 a_cd2
    s_waitcnt lgkmcnt(0)
    v_add_u32 v29, v15, v27
    v_cmp_lt_u32_sdwa vcc, v1, v19 src0_sel:DWORD src1_sel:WORD_0
    v_cmp_ge_u32_sdwa s[40:41], v1, v19 src0_sel:DWORD src1_sel:WORD_1
    v_cmp_lt_u32_sdwa s[42:43], v2, v19 src0_sel:DWORD src1_sel:WORD_0
    s_or_b64 exec, vcc, 1
    buffer_load_dwordx3 v[8:10], v29, s[8:11], 0 offen
    s_mov_b64 exec, -1
    s_and_b64 s[40:41], s[40:41], vcc
    s_cmp_lg_u32 s32, 0
    s_cbranch_scc1 a_li2_have
    s_cmp_lg_u32 s22, -1
    s_cbranch_scc1 a_li2_none
    v_and_b32 v28, 0xffff, v11
    v_subrev_u32 v28, 192, v28
    v_max_i32 v11, 0, v28
    v_add_u32 v7, 384, v7
    v_cmp_lt_u32 vcc, 0, v11
    s_or_b32 s32, vcc_lo, vcc_hi
    s_cbranch_scc1 a_li2_have
    s_mov_b32 s22, 6
    s_branch a_li2_none
a_li2_have:
    s_ff1_i32_b32 s26, s32
    s_bitset0_b32 s32, s26
    s_lshl_b32 s26, s26, 2
    v_add_u32 v28, s26, v23
    ds_bpermute_b32 v15, v28, v7
    ds_bpermute_b32 v19, v28, v11
a_li2_none:
    s_waitcnt vmcnt(5)
    s_branch a_go2
a_cd2:
    s_sub_u32 s22, s22, 1
    s_cmp_eq_u32 s22, 0
    s_cbranch_scc1 a_end
    s_mov_b64 s[40:41], 0
    s_mov_b64 s[42:43], 0
    s_waitcnt vmcnt(0)
a_go2:
    v_lshlrev_b32_sdwa v36, 2, v12 dst_sel:DWORD dst_unused:UNUSED_PAD src0_sel:DWORD src1_sel:BYTE_3
    v_lshlrev_b32_sdwa v37, 2, v14 dst_sel:DWORD dst_unused:UNUSED_PAD src0_sel:DWORD src1_sel:BYTE_3
    s_mov_b64 exec, s[44:45]
    ds_add_rtn_u32 v34, v36, v3 offset:0
    s_mov_b64 exec, s[46:47]
    ds_add_rtn_u32 v35, v37, v3 offset:0
    s_mov_b64 exec, -1
    v_mul_u32_u24_sdwa v32, s34, v12 dst_sel:DWORD dst_unused:UNUSED_PAD src0_sel:DWORD src1_sel:BYTE_3
    v_mul_u32_u24_sdwa v33, s34, v14 dst_sel:DWORD dst_unused:UNUSED_PAD src0_sel:DWORD src1_sel:BYTE_3
    s_waitcnt lgkmcnt(0)
    v_cmp_lt_u32 vcc, 0xff, v34
    s_and_b64 s[28:29], vcc, s[44:45]
    v_cmp_lt_u32 vcc, 0xff, v35
    s_and_b64 s[30:31], vcc, s[46:47]
    s_or_b64 vcc, s[28:29], s[30:31]
    s_cbranch_scc0 a_noovf2
    v_mov_b32 v36, 0
    s_mov_b64 exec, s[28:29]
    ds_add_rtn_u32 v34, v36, v3 offset:1008
    s_mov_b64 exec, s[30:31]
    ds_add_rtn_u32 v35, v36, v3 offset:1008
    s_waitcnt lgkmcnt(0)
    v_lshrrev_b32 v33, 8, v35
    v_cmp_le_u32 vcc, 13, v33
    v_add_u32 v33, 196, v33
    v_mul_u32_u24 v33, s34, v33
    v_and_b32 v35, 0xff, v35
    s_mov_b64 s[30:31], vcc
    s_mov_b64 exec, s[28:29]
    v_lshrrev_b32 v32, 8, v34
    v_cmp_le_u32 vcc, 13, v32
    v_add_u32 v32, 196, v32
    v_mul_u32_u24 v32, s34, v32
    v_and_b32 v34, 0xff, v34
    s_mov_b64 s[28:29], vcc
    s_mov_b64 exec, -1
    s_or_b64 vcc, s[28:29], s[30:31]
    s_cbranch_scc0 a_noovf2
    s_mov_b64 s[18:19], s[28:29]
    s_mov_b64 s[20:21], s[30:31]
    s_andn2_b64 s[44:45], s[44:45], s[28:29]
    s_andn2_b64 s[46:47], s[46:47], s[30:31]
    s_mov_b32 s33, 1
a_noovf2:
    v_lshl_add_u32 v36, v34, 1, v32
    v_lshl_add_u32 v37, v35, 1, v33
    v_add_u32 v34, v34, v32
    v_add_u32 v35, v35, v33
    s_mov_b64 exec, s[44:45]
    ds_write_b32 v36, v12 offset:1024
    ds_write_b16 v34, v13 offset:1536
    s_mov_b64 exec, s[46:47]
    ds_write_b32 v37, v14 offset:1024
    ds_write_b16_d16_hi v35, v13 offset:1536
    s_mov_b64 exec, -1
    s_cmp_lg_u32 s33, 0
    s_cbranch_scc1 a_stop
    s_add_u32 s17, s17, 1
    s_cmp_lt_u32 s17, 3
    s_cbranch_scc1 a_pr3
    s_setprio 2
    s_cmp_lt_u32 s17, 6
    s_cbranch_scc1 a_pr3
    s_setprio 1
    s_cmp_lt_u32 s17, 9
    s_cbranch_scc1 a_pr3
    s_setprio 0
a_pr3:
    s_cmp_lg_u32 s22, -1
    s_cbranch_scc1 a_cd3
    s_waitcnt lgkmcnt(0)
    v_add_u32 v29, v15, v27
    v_cmp_lt_u32_sdwa vcc, v1, v19 src0_sel:DWORD src1_sel:WORD_0
    v_cmp_ge_u32_sdwa s[44:45], v1, v19 src0_sel:DWORD src1_sel:WORD_1
    v_cmp_lt_u32_sdwa s[46:47], v2, v19 src0_sel:DWORD src1_sel:WORD_0
    s_or_b64 exec, vcc, 1
    buffer_load_dwordx3 v[12:14], v29, s[8:11], 0 offen
    s_mov_b64 exec, -1
    s_and_b64 s[44:45], s[44:45], vcc
    s_cmp_lg_u32 s32, 0
    s_cbranch_scc1 a_li3_have
    s_cmp_lg_u32 s22, -1
    s_cbranch_scc1 a_li3_none
    v_and_b32 v28, 0xffff, v11
    v_subrev_u32 v28, 192, v28
    v_max_i32 v11, 0, v28
    v_add_u32 v7, 384, v7
    v_cmp_lt_u32 vcc, 0, v11
    s_or_b32 s32, vcc_lo, vcc_hi
    s_cbranch_scc1 a_li3_have
    s_mov_b32 s22, 6
    s_branch a_li3_none
a_li3_have:
    s_ff1_i32_b32 s26, s32
    s_bitset0_b32 s32, s26
    s_lshl_b32 s26, s26, 2
    v_add_u32 v28, s26, v23
    ds_bpermute_b32 v15, v28, v7
    ds_bpermute_b32 v19, v28, v11
a_li3_none:
    s_waitcnt vmcnt(5)
    s_branch a_go3
a_cd3:
    s_sub_u32 s22, s22, 1
    s_cmp_eq_u32 s22, 0
    s_cbranch_scc1 a_end
    s_mov_b64 s[44:45], 0
    s_mov_b64 s[46:47], 0
    s_waitcnt vmcnt(0)
a_go3:
    v_lshlrev_b32_sdwa v36, 2, v16 dst_sel:DWORD dst_unused:UNUSED_PAD src0_sel:DWORD src1_sel:BYTE_3
    v_lshlrev_b32_sdwa v37, 2, v18 dst_sel:DWORD dst_unused:UNUSED_PAD src0_sel:DWORD src1_sel:BYTE_3
    s_mov_b64 exec, s[48:49]
    ds_add_rtn_u32 v34, v36, v3 offset:0
    s_mov_b64 exec, s[50:51]
    ds_add_rtn_u32 v35, v37, v3 offset:0
    s_mov_b64 exec, -1
    v_mul_u32_u24_sdwa v32, s34, v16 dst_sel:DWORD dst_unused:UNUSED_PAD src0_sel:DWORD src1_sel:BYTE_3
    v_mul_u32_u24_sdwa v33, s34, v18 dst_sel:DWORD dst_unused:UNUSED_PAD src0_sel:DWORD src1_sel:BYTE_3
    s_waitcnt lgkmcnt(0)
    v_cmp_lt_u32 vcc, 0xff, v34
    s_and_b64 s[28:29], vcc, s[48:49]
    v_cmp_lt_u32 vcc, 0xff, v35
    s_and_b64 s[30:31], vcc, s[50:51]
    s_or_b64 vcc, s[28:29], s[30:31]
    s_cbranch_scc0 a_noovf3
    v_mov_b32 v36, 0
    s_mov_b64 exec, s[28:29]
    ds_add_rtn_u32 v34, v36, v3 offset:1008
    s_mov_b64 exec, s[30:31]
    ds_add_rtn_u32 v35, v36, v3 offset:1008
    s_waitcnt lgkmcnt(0)
    v_lshrrev_b32 v33, 8, v35
    v_cmp_le_u32 vcc, 13, v33
    v_add_u32 v33, 196, v33
    v_mul_u32_u24 v33, s34, v33
    v_and_b32 v35, 0xff, v35
    s_mov_b64 s[30:31], vcc
    s_mov_b64 exec, s[28:29]
    v_lshrrev_b32 v32, 8, v34
    v_cmp_le_u32 vcc, 13, v32
    v_add_u32 v32, 196, v32
    v_mul_u32_u24 v32, s34, v32
    v_and_b32 v34, 0xff, v34
    s_mov_b64 s[28:29], vcc
    s_mov_b64 exec, -1
    s_or_b64 vcc, s[28:29], s[30:31]
    s_cbranch_scc0 a_noovf3
    s_mov_b64 s[18:19], s[28:29]
    s_mov_b64 s[20:21], s[30:31]
    s_andn2_b64 s[48:49], s[48:49], s[28:29]
    s_andn2_b64 s[50:51], s[50:51], s[30:31]
    s_mov_b32 s33, 1
a_noovf3:
    v_lshl_add_u32 v36, v34, 1, v32
    v_lshl_add_u32 v37, v35, 1, v33
    v_add_u32 v34, v34, v32
    v_add_u32 v35, v35, v33
    s_mov_b64 exec, s[48:49]
    ds_write_b32 v36, v16 offset:1024
    ds_write_b16 v34, v17 offset:1536
    s_mov_b64 exec, s[50:51]
    ds_write_b32 v37, v18 offset:1024
    ds_write_b16_d16_hi v35, v17 offset:1536
    s_mov_b64 exec, -1
    s_cmp_lg_u32 s33, 0
    s_cbranch_scc1 a_stop
    s_add_u32 s17, s17, 1
    s_cmp_lt_u32 s17, 3
    s_cbranch_scc1 a_pr4
    s_setprio 2
    s_cmp_lt_u32 s17, 6
    s_cbranch_scc1 a_pr4
    s_setprio 1
    s_cmp_lt_u32 s17, 9
    s_cbranch_scc1 a_pr4
    s_setprio 0
a_pr4:
    s_cmp_lg_u32 s22, -1
    s_cbranch_scc1 a_cd4
    s_waitcnt lgkmcnt(0)
    v_add_u32 v29, v15, v27
    v_cmp_lt_u32_sdwa vcc, v1, v19 src0_sel:DWORD src1_sel:WORD_0
    v_cmp_ge_u32_sdwa s[48:49], v1, v19 src0_sel:DWORD src1_sel:WORD_1
    v_cmp_lt_u32_sdwa s[50:51], v2, v19 src0_sel:DWORD src1_sel:WORD_0
    s_or_b64 exec, vcc, 1
    buffer_load_dwordx3 v[16:18], v29, s[8:11], 0 offen
    s_mov_b64 exec, -1
    s_and_b64 s[48:49], s[48:49], vcc
    s_cmp_lg_u32 s32, 0
    s_cbranch_scc1 a_li4_have
    s_cmp_lg_u32 s22, -1
    s_cbranch_scc1 a_li4_none
    v_and_b32 v28, 0xffff, v11
    v_subrev_u32 v28, 192, v28
    v_max_i32 v11, 0, v28
    v_add_u32 v7, 384, v7
    v_cmp_lt_u32 vcc, 0, v11
    s_or_b32 s32, vcc_lo, vcc_hi
    s_cbranch_scc1 a_li4_have
    s_mov_b32 s22, 6
    s_branch a_li4_none
a_li4_have:
    s_ff1_i32_b32 s26, s32
    s_bitset0_b32 s32, s26
    s_lshl_b32 s26, s26, 2
    v_add_u32 v28, s26, v23
    ds_bpermute_b32 v15, v28, v7
    ds_bpermute_b32 v19, v28, v11
a_li4_none:
    s_waitcnt vmcnt(5)
    s_branch a_go4
a_cd4:
    s_sub_u32 s22, s22, 1
    s_cmp_eq_u32 s22, 0
    s_cbranch_scc1 a_end
    s_mov_b64 s[48:49], 0
    s_mov_b64 s[50:51], 0
    s_waitcnt vmcnt(0)
a_go4:
    v_lshlrev_b32_sdwa v36, 2, v20 dst_sel:DWORD dst_unused:UNUSED_PAD src0_sel:DWORD src1_sel:BYTE_3
    v_lshlrev_b32_sdwa v37, 2, v22 dst_sel:DWORD dst_unused:UNUSED_PAD src0_sel:DWORD src1_sel:BYTE_3
    s_mov_b64 exec, s[52:53]
    ds_add_rtn_u32 v34, v36, v3 offset:0
    s_mov_b64 exec, s[54:55]
    ds_add_rtn_u32 v35, v37, v3 offset:0
    s_mov_b64 exec, -1
    v_mul_u32_u24_sdwa v32, s34, v20 dst_sel:DWORD dst_unused:UNUSED_PAD src0_sel:DWORD src1_sel:BYTE_3
    v_mul_u32_u24_sdwa v33, s34, v22 dst_sel:DWORD dst_unused:UNUSED_PAD src0_sel:DWORD src1_sel:BYTE_3
    s_waitcnt lgkmcnt(0)
    v_cmp_lt_u32 vcc, 0xff, v34
    s_and_b64 s[28:29], vcc, s[52:53]
    v_cmp_lt_u32 vcc, 0xff, v35
    s_and_b64 s[30:31], vcc, s[54:55]
    s_or_b64 vcc, s[28:29], s[30:31]
    s_cbranch_scc0 a_noovf4
    v_mov_b32 v36, 0
    s_mov_b64 exec, s[28:29]
    ds_add_rtn_u32 v34, v36, v3 offset:1008
    s_mov_b64 exec, s[30:31]
    ds_add_rtn_u32 v35, v36, v3 offset:1008
    s_waitcnt lgkmcnt(0)
    v_lshrrev_b32 v33, 8, v35
    v_cmp_le_u32 vcc, 13, v33
    v_add_u32 v33, 196, v33
    v_mul_u32_u24 v33, s34, v33
    v_and_b32 v35, 0xff, v35
    s_mov_b64 s[30:31], vcc
    s_mov_b64 exec, s[28:29]
    v_lshrrev_b32 v32, 8, v34
    v_cmp_le_u32 vcc, 13, v32
    v_add_u32 v32, 196, v32
    v_mul_u32_u24 v32, s34, v32
    v_and_b32 v34, 0xff, v34
    s_mov_b64 s[28:29], vcc
    s_mov_b64 exec, -1
    s_or_b64 vcc, s[28:29], s[30:31]
    s_cbranch_scc0 a_noovf4
    s_mov_b64 s[18:19], s[28:29]
    s_mov_b64 s[20:21], s[30:31]
    s_andn2_b64 s[52:53], s[52:53], s[28:29]
    s_andn2_b64 s[54:55], s[54:55], s[30:31]
    s_mov_b32 s33, 1
a_noovf4:
    v_lshl_add_u32 v36, v34, 1, v32
    v_lshl_add_u32 v37, v35, 1, v33
    v_add_u32 v34, v34, v32
    v_add_u32 v35, v35, v33
    s_mov_b64 exec, s[52:53]
    ds_write_b32 v36, v20 offset:1024
    ds_write_b16 v34, v21 offset:1536
    s_mov_b64 exec, s[54:55]
    ds_write_b32 v37, v22 offset:1024
    ds_write_b16_d16_hi v35, v21 offset:1536
    s_mov_b64 exec, -1
    s_cmp_lg_u32 s33, 0
    s_cbranch_scc1 a_stop
    s_add_u32 s17, s17, 1
    s_cmp_lt_u32 s17, 3
    s_cbranch_scc1 a_pr5
    s_setprio 2
    s_cmp_lt_u32 s17, 6
    s_cbranch_scc1 a_pr5
    s_setprio 1
    s_cmp_lt_u32 s17, 9
    s_cbranch_scc1 a_pr5
    s_setprio 0
a_pr5:
    s_cmp_lg_u32 s22, -1
    s_cbranch_scc1 a_cd5
    s_waitcnt lgkmcnt(0)
    v_add_u32 v29, v15, v27
    v_cmp_lt_u32_sdwa vcc, v1, v19 src0_sel:DWORD src1_sel:WORD_0
    v_cmp_ge_u32_sdwa s[52:53], v1, v19 src0_sel:DWORD src1_sel:WORD_1
    v_cmp_lt_u32_sdwa s[54:55], v2, v19 src0_sel:DWORD src1_sel:WORD_0
    s_or_b64 exec, vcc, 1
    buffer_load_dwordx3 v[20:22], v29, s[8:11], 0 offen
    s_mov_b64 exec, -1
    s_and_b64 s[52:53], s[52:53], vcc
    s_cmp_lg_u32 s32, 0
    s_cbranch_scc1 a_li5_have
    s_cmp_lg_u32 s22, -1
    s_cbranch_scc1 a_li5_none
    v_and_b32 v28, 0xffff, v11
    v_subrev_u32 v28, 192, v28
    v_max_i32 v11, 0, v28
    v_add_u32 v7, 384, v7
    v_cmp_lt_u32 vcc, 0, v11
    s_or_b32 s32, vcc_lo, vcc_hi
    s_cbranch_scc1 a_li5_have
    s_mov_b32 s22, 6
    s_branch a_li5_none
a_li5_have:
    s_ff1_i32_b32 s26, s32
    s_bitset0_b32 s32, s26
    s_lshl_b32 s26, s26, 2
    v_add_u32 v28, s26, v23
    ds_bpermute_b32 v15, v28, v7
    ds_bpermute_b32 v19, v28, v11
a_li5_none:
    s_waitcnt vmcnt(5)
    s_branch a_go5
a_cd5:
    s_sub_u32 s22, s22, 1
    s_cmp_eq_u32 s22, 0
    s_cbranch_scc1 a_end
    s_mov_b64 s[52:53], 0
    s_mov_b64 s[54:55], 0
    s_waitcnt vmcnt(0)
a_go5:
    v_lshlrev_b32_sdwa v36, 2, v24 dst_sel:DWORD dst_unused:UNUSED_PAD src0_sel:DWORD src1_sel:BYTE_3
    v_lshlrev_b32_sdwa v37, 2, v26 dst_sel:DWORD dst_unused:UNUSED_PAD src0_sel:DWORD src1_sel:BYTE_3
    s_mov_b64 exec, s[56:57]
    ds_add_rtn_u32 v34, v36, v3 offset:0
    s_mov_b64 exec, s[58:59]
    ds_add_rtn_u32 v35, v37, v3 offset:0
    s_mov_b64 exec, -1
    v_mul_u32_u24_sdwa v32, s34, v24 dst_sel:DWORD dst_unused:UNUSED_PAD src0_sel:DWORD src1_sel:BYTE_3
    v_mul_u32_u24_sdwa v33, s34, v26 dst_sel:DWORD dst_unused:UNUSED_PAD src0_sel:DWORD src1_sel:BYTE_3
    s_waitcnt lgkmcnt(0)
    v_cmp_lt_u32 vcc, 0xff, v34
    s_and_b64 s[28:29], vcc, s[56:57]
    v_cmp_lt_u32 vcc, 0xff, v35
    s_and_b64 s[30:31], vcc, s[58:59]
    s_or_b64 vcc, s[28:29], s[30:31]
    s_cbranch_scc0 a_noovf5
    v_mov_b32 v36, 0
    s_mov_b64 exec, s[28:29]
    ds_add_rtn_u32 v34, v36, v3 offset:1008
    s_mov_b64 exec, s[30:31]
    ds_add_rtn_u32 v35, v36, v3 offset:1008
    s_waitcnt lgkmcnt(0)
    v_lshrrev_b32 v33, 8, v35
    v_cmp_le_u32 vcc, 13, v33
    v_add_u32 v33, 196, v33
    v_mul_u32_u24 v33, s34, v33
    v_and_b32 v35, 0xff, v35
    s_mov_b64 s[30:31], vcc
    s_mov_b64 exec, s[28:29]
    v_lshrrev_b32 v32, 8, v34
    v_cmp_le_u32 vcc, 13, v32
    v_add_u32 v32, 196, v32
    v_mul_u32_u24 v32, s34, v32
    v_and_b32 v34, 0xff, v34
    s_mov_b64 s[28:29], vcc
    s_mov_b64 exec, -1
    s_or_b64 vcc, s[28:29], s[30:31]
    s_cbranch_scc0 a_noovf5
    s_mov_b64 s[18:19], s[28:29]
    s_mov_b64 s[20:21], s[30:31]
    s_andn2_b64 s[56:57], s[56:57], s[28:29]
    s_andn2_b64 s[58:59], s[58:59], s[30:31]
    s_mov_b32 s33, 1
a_noovf5:
    v_lshl_add_u32 v36, v34, 1, v32
    v_lshl_add_u32 v37, v35, 1, v33
    v_add_u32 v34, v34, v32
    v_add_u32 v35, v35, v33
    s_mov_b64 exec, s[56:57]
    ds_write_b32 v36, v24 offset:1024
    ds_write_b16 v34, v25 offset:1536
    s_mov_b64 exec, s[58:59]
    ds_write_b32 v37, v26 offset:1024
    ds_write_b16_d16_hi v35, v25 offset:1536
    s_mov_b64 exec, -1
    s_cmp_lg_u32 s33, 0
    s_cbranch_scc1 a_stop
    s_add_u32 s17, s17, 1
    s_branch a_loop
a_stop:
    v_mov_b32 v28, 0
    v_mov_b32 v29, 1
    ds_write_b32 v28, v29 offset:1012
a_end:
    s_add_u32 s16, s16, s17
    s_load_dwordx2 s[60:61], s[0:1], 24
    s_load_dwordx2 s[64:65], s[0:1], 40
    s_load_dwordx2 s[68:69], s[0:1], 0
    s_waitcnt vmcnt(0) lgkmcnt(0)
    s_load_dwordx4 s[64:67], s[64:65], 0
    s_and_b32 s61, s61, 0xffff
    s_mov_b32 s62, 800000
    s_mov_b32 s63, 0x00020000
    s_and_b32 s69, s69, 0xffff
    s_mov_b32 s70, 3200000
    s_mov_b32 s71, 0x00020000
    s_barrier
    v_mov_b32 v28, 0
    ds_read_b64 v[30:31], v28 offset:1008
    s_mov_b32 s34, 0xffff0000
    s_cmp_ge_u32 s3, 8
    s_cbranch_scc1 b_consumer
    v_and_b32 v4, 63, v0
    s_add_u32 s26, s3, s35
    v_mul_u32_u24 v5, 8, v4
    v_add_u32 v5, s26, v5
    v_subrev_u32 v6, 216, v5
    v_min_u32 v5, v5, v6
    v_min_u32 v6, 195, v5
    v_lshlrev_b32 v6, 2, v6
    ds_read_b32 v20, v6 offset:0
    v_lshlrev_b32 v7, 3, v4
    v_lshlrev_b32 v21, 2, v4
    s_mul_i32 s26, s26, 776
    s_mov_b32 s28, s26
    v_add_u32 v10, s28, v7
    v_add_u32 v11, s28, v21
    s_add_u32 s28, s28, 6208
    s_sub_u32 s29, s28, 167616
    s_min_u32 s28, s28, s29
    ds_read_b64 v[48:49], v10 offset:1024
    ds_read_b32 v102, v11 offset:1536
    v_add_u32 v12, s28, v7
    v_add_u32 v13, s28, v21
    s_add_u32 s28, s28, 6208
    s_sub_u32 s29, s28, 167616
    s_min_u32 s28, s28, s29
    ds_read_b64 v[50:51], v12 offset:1024
    ds_read_b32 v103, v13 offset:1536
    v_subrev_u32 v9, 196, v5
    v_lshlrev_b32 v9, 8, v9
    v_cmp_gt_u32 vcc, 196, v5
    s_waitcnt lgkmcnt(0)
    v_readfirstlane_b32 s23, v31
    v_min_u32 v30, 3328, v30
    v_sub_u32 v9, v30, v9
    v_max_i32 v9, 0, v9
    v_cndmask_b32 v20, v9, v20, vcc
    v_min_u32 v20, 0x100, v20
    s_setprio 3
    v_readlane_b32 s26, v20, 0
    v_lshrrev_b32 v4, 13, v48
    v_lshrrev_b32 v5, 13, v49
    s_sub_u32 s27, s26, 2
    v_cmp_gt_u32 s[36:37], s26, v21
    v_cmp_gt_i32 s[38:39], s27, v21
    s_or_b64 exec, s[36:37], 1
    buffer_load_dwordx2 v[24:25], v4, s[4:7], 0 idxen
    s_or_b64 exec, s[38:39], 1
    buffer_load_dwordx2 v[28:29], v5, s[4:7], 0 idxen
    s_mov_b64 exec, -1
    v_readlane_b32 s26, v20, 1
    v_lshrrev_b32 v4, 13, v50
    v_lshrrev_b32 v5, 13, v51
    s_sub_u32 s27, s26, 2
    v_cmp_gt_u32 s[40:41], s26, v21
    v_cmp_gt_i32 s[42:43], s27, v21
    s_or_b64 exec, s[40:41], 1
    buffer_load_dwordx2 v[32:33], v4, s[4:7], 0 idxen
    s_or_b64 exec, s[42:43], 1
    buffer_load_dwordx2 v[36:37], v5, s[4:7], 0 idxen
    s_mov_b64 exec, -1
    v_add_u32 v10, s28, v7
    v_add_u32 v11, s28, v21
    s_add_u32 s28, s28, 6208
    s_sub_u32 s29, s28, 167616
    s_min_u32 s28, s28, s29
    ds_read_b64 v[52:53], v10 offset:1024
    ds_read_b32 v104, v11 offset:1536
    v_add_u32 v12, s28, v7
    v_add_u32 v13, s28, v21
    s_add_u32 s28, s28, 6208
    s_sub_u32 s29, s28, 167616
    s_min_u32 s28, s28, s29
    ds_read_b64 v[54:55], v12 offset:1024
    ds_read_b32 v105, v13 offset:1536
    v_add_u32 v10, s28, v7
    v_add_u32 v11, s28, v21
    s_add_u32 s28, s28, 6208
    s_sub_u32 s29, s28, 167616
    s_min_u32 s28, s28, s29
    ds_read_b64 v[56:57], v10 offset:1024
    ds_read_b32 v106, v11 offset:1536
    v_add_u32 v12, s28, v7
    v_add_u32 v13, s28, v21
    s_add_u32 s28, s28, 6208
    s_sub_u32 s29, s28, 167616
    s_min_u32 s28, s28, s29
    ds_read_b64 v[58:59], v12 offset:1024
    ds_read_b32 v107, v13 offset:1536
    v_add_u32 v10, s28, v7
    v_add_u32 v11, s28, v21
    s_add_u32 s28, s28, 6208
    s_sub_u32 s29, s28, 167616
    s_min_u32 s28, s28, s29
    ds_read_b64 v[60:61], v10 offset:1024
    ds_read_b32 v108, v11 offset:1536
    v_add_u32 v12, s28, v7
    v_add_u32 v13, s28, v21
    s_add_u32 s28, s28, 6208
    s_sub_u32 s29, s28, 167616
    s_min_u32 s28, s28, s29
    ds_read_b64 v[62:63], v12 offset:1024
    ds_read_b32 v109, v13 offset:1536
    v_add_u32 v10, s28, v7
    v_add_u32 v11, s28, v21
    s_add_u32 s28, s28, 6208
    s_sub_u32 s29, s28, 167616
    s_min_u32 s28, s28, s29
    ds_read_b64 v[64:65], v10 offset:1024
    ds_read_b32 v110, v11 offset:1536
    v_add_u32 v12, s28, v7
    v_add_u32 v13, s28, v21
    s_add_u32 s28, s28, 6208
    s_sub_u32 s29, s28, 167616
    s_min_u32 s28, s28, s29
    ds_read_b64 v[66:67], v12 offset:1024
    ds_read_b32 v111, v13 offset:1536
    v_add_u32 v10, s28, v7
    v_add_u32 v11, s28, v21
    s_add_u32 s28, s28, 6208
    s_sub_u32 s29, s28, 167616
    s_min_u32 s28, s28, s29
    ds_read_b64 v[68:69], v10 offset:1024
    ds_read_b32 v112, v11 offset:1536
    v_add_u32 v12, s28, v7
    v_add_u32 v13, s28, v21
    s_add_u32 s28, s28, 6208
    s_sub_u32 s29, s28, 167616
    s_min_u32 s28, s28, s29
    ds_read_b64 v[70:71], v12 offset:1024
    ds_read_b32 v113, v13 offset:1536
    v_add_u32 v10, s28, v7
    v_add_u32 v11, s28, v21
    s_add_u32 s28, s28, 6208
    s_sub_u32 s29, s28, 167616
    s_min_u32 s28, s28, s29
    ds_read_b64 v[72:73], v10 offset:1024
    ds_read_b32 v114, v11 offset:1536
    v_add_u32 v12, s28, v7
    v_add_u32 v13, s28, v21
    s_add_u32 s28, s28, 6208
    s_sub_u32 s29, s28, 167616
    s_min_u32 s28, s28, s29
    ds_read_b64 v[74:75], v12 offset:1024
    ds_read_b32 v115, v13 offset:1536
    v_add_u32 v10, s28, v7
    v_add_u32 v11, s28, v21
    s_add_u32 s28, s28, 6208
    s_sub_u32 s29, s28, 167616
    s_min_u32 s28, s28, s29
    ds_read_b64 v[76:77], v10 offset:1024
    ds_read_b32 v116, v11 offset:1536
    v_add_u32 v12, s28, v7
    v_add_u32 v13, s28, v21
    s_add_u32 s28, s28, 6208
    s_sub_u32 s29, s28, 167616
    s_min_u32 s28, s28, s29
    ds_read_b64 v[78:79], v12 offset:1024
    ds_read_b32 v117, v13 offset:1536
    v_add_u32 v10, s28, v7
    v_add_u32 v11, s28, v21
    s_add_u32 s28, s28, 6208
    s_sub_u32 s29, s28, 167616
    s_min_u32 s28, s28, s29
    ds_read_b64 v[80:81], v10 offset:1024
    ds_read_b32 v118, v11 offset:1536
    v_add_u32 v12, s28, v7
    v_add_u32 v13, s28, v21
    s_add_u32 s28, s28, 6208
    s_sub_u32 s29, s28, 167616
    s_min_u32 s28, s28, s29
    ds_read_b64 v[82:83], v12 offset:1024
    ds_read_b32 v119, v13 offset:1536
    v_add_u32 v10, s28, v7
    v_add_u32 v11, s28, v21
    s_add_u32 s28, s28, 6208
    s_sub_u32 s29, s28, 167616
    s_min_u32 s28, s28, s29
    ds_read_b64 v[84:85], v10 offset:1024
    ds_read_b32 v120, v11 offset:1536
    v_add_u32 v12, s28, v7
    v_add_u32 v13, s28, v21
    s_add_u32 s28, s28, 6208
    s_sub_u32 s29, s28, 167616
    s_min_u32 s28, s28, s29
    ds_read_b64 v[86:87], v12 offset:1024
    ds_read_b32 v121, v13 offset:1536
    v_add_u32 v10, s28, v7
    v_add_u32 v11, s28, v21
    s_add_u32 s28, s28, 6208
    s_sub_u32 s29, s28, 167616
    s_min_u32 s28, s28, s29
    ds_read_b64 v[88:89], v10 offset:1024
    ds_read_b32 v122, v11 offset:1536
    v_add_u32 v12, s28, v7
    v_add_u32 v13, s28, v21
    s_add_u32 s28, s28, 6208
    s_sub_u32 s29, s28, 167616
    s_min_u32 s28, s28, s29
    ds_read_b64 v[90:91], v12 offset:1024
    ds_read_b32 v123, v13 offset:1536
    v_add_u32 v10, s28, v7
    v_add_u32 v11, s28, v21
    s_add_u32 s28, s28, 6208
    s_sub_u32 s29, s28, 167616
    s_min_u32 s28, s28, s29
    ds_read_b64 v[92:93], v10 offset:1024
    ds_read_b32 v124, v11 offset:1536
    v_add_u32 v12, s28, v7
    v_add_u32 v13, s28, v21
    s_add_u32 s28, s28, 6208
    s_sub_u32 s29, s28, 167616
    s_min_u32 s28, s28, s29
    ds_read_b64 v[94:95], v12 offset:1024
    ds_read_b32 v125, v13 offset:1536
    v_add_u32 v10, s28, v7
    v_add_u32 v11, s28, v21
    s_add_u32 s28, s28, 6208
    s_sub_u32 s29, s28, 167616
    s_min_u32 s28, s28, s29
    ds_read_b64 v[96:97], v10 offset:1024
    ds_read_b32 v126, v11 offset:1536
    v_add_u32 v12, s28, v7
    v_add_u32 v13, s28, v21
    s_add_u32 s28, s28, 6208
    s_sub_u32 s29, s28, 167616
    s_min_u32 s28, s28, s29
    ds_read_b64 v[98:99], v12 offset:1024
    ds_read_b32 v127, v13 offset:1536
    v_add_u32 v10, s28, v7
    v_add_u32 v11, s28, v21
    s_add_u32 s28, s28, 6208
    s_sub_u32 s29, s28, 167616
    s_min_u32 s28, s28, s29
    ds_read_b64 v[100:101], v10 offset:1024
    ds_read_b32 v23, v11 offset:1536
    s_waitcnt lgkmcnt(0)
    s_barrier
    v_mov_b32 v16, 0.15915494
    v_mov_b32 v17, 0x40400000
    v_mov_b32 v18, -1.0
    v_mov_b32 v19, 0xffff0000
    s_mul_i32 s26, s3, 18432
    s_add_u32 s26, s26, 13056
    v_lshlrev_b32 v2, 2, v21
    v_add_u32 v2, s26, v2
    v_lshrrev_b32 v1, 4, v2
    s_barrier
    s_setprio 2
    v_readlane_b32 s26, v20, 2
    v_lshrrev_b32 v4, 13, v52
    v_lshrrev_b32 v5, 13, v53
    s_sub_u32 s27, s26, 2
    v_cmp_gt_u32 s[44:45], s26, v21
    v_cmp_gt_i32 s[46:47], s27, v21
    s_or_b64 exec, s[44:45], 1
    buffer_load_dwordx2 v[40:41], v4, s[4:7], 0 idxen
    s_or_b64 exec, s[46:47], 1
    buffer_load_dwordx2 v[44:45], v5, s[4:7], 0 idxen
    s_mov_b64 exec, -1
    v_and_b32 v14, 0x1ffc, v48
    v_and_b32 v15, 0x1ffc, v49
    v_add_u32 v4, 0, v1
    v_add_u32 v5, 64, v1
    s_mov_b64 exec, s[36:37]
    ds_wrxchg_rtn_b32 v27, v14, v4 offset:0
    s_mov_b64 exec, s[38:39]
    ds_wrxchg_rtn_b32 v31, v15, v5 offset:0
    s_mov_b64 exec, -1
    v_lshlrev_b32 v6, 16, v102
    v_and_b32 v7, s34, v102
    v_pk_mul_f32 v[12:13], v[6:7], v[16:17] op_sel:[0,1] op_sel_hi:[1,1]
    v_pk_mul_f32 v[8:9], v[6:7], v[16:17] op_sel:[0,0] op_sel_hi:[1,0]
    v_cvt_pk_bf16_f32 v13, v12, v13
    v_fract_f32 v8, v8
    v_fract_f32 v9, v9
    v_lshlrev_b32 v12, 16, v13
    v_and_b32 v13, s34, v13
    v_cos_f32 v8, v8
    v_cos_f32 v9, v9
    v_pk_mul_f32 v[12:13], v[12:13], v[16:17] op_sel:[0,0] op_sel_hi:[1,0]
    v_pk_add_f32 v[10:11], v[8:9], v[8:9]
    v_fract_f32 v12, v12
    v_fract_f32 v13, v13
    v_pk_fma_f32 v[10:11], v[10:11], v[8:9], v[18:19] op_sel:[0,0,0] op_sel_hi:[1,1,0]
    v_cos_f32 v12, v12
    v_cos_f32 v13, v13
    v_cvt_pk_bf16_f32 v26, v8, v10
    v_cvt_pk_bf16_f32 v30, v9, v11
    v_cvt_pk_bf16_f32 v4, v12, v13
    s_waitcnt lgkmcnt(0)
    v_lshl_or_b32 v27, v4, 16, v27
    v_and_or_b32 v31, v4, v19, v31
    s_waitcnt vmcnt(4)
    ds_write_b128 v2, v[24:27] offset:0
    ds_write_b128 v2, v[28:31] offset:1024
    s_setprio 2
    v_readlane_b32 s26, v20, 3
    v_lshrrev_b32 v4, 13, v54
    v_lshrrev_b32 v5, 13, v55
    s_sub_u32 s27, s26, 2
    v_cmp_gt_u32 s[48:49], s26, v21
    v_cmp_gt_i32 s[50:51], s27, v21
    s_or_b64 exec, s[48:49], 1
    buffer_load_dwordx2 v[24:25], v4, s[4:7], 0 idxen
    s_or_b64 exec, s[50:51], 1
    buffer_load_dwordx2 v[28:29], v5, s[4:7], 0 idxen
    s_mov_b64 exec, -1
    v_and_b32 v14, 0x1ffc, v50
    v_and_b32 v15, 0x1ffc, v51
    v_add_u32 v4, 128, v1
    v_add_u32 v5, 192, v1
    s_mov_b64 exec, s[40:41]
    ds_wrxchg_rtn_b32 v35, v14, v4 offset:0
    s_mov_b64 exec, s[42:43]
    ds_wrxchg_rtn_b32 v39, v15, v5 offset:0
    s_mov_b64 exec, -1
    v_lshlrev_b32 v6, 16, v103
    v_and_b32 v7, s34, v103
    v_pk_mul_f32 v[12:13], v[6:7], v[16:17] op_sel:[0,1] op_sel_hi:[1,1]
    v_pk_mul_f32 v[8:9], v[6:7], v[16:17] op_sel:[0,0] op_sel_hi:[1,0]
    v_cvt_pk_bf16_f32 v13, v12, v13
    v_fract_f32 v8, v8
    v_fract_f32 v9, v9
    v_lshlrev_b32 v12, 16, v13
    v_and_b32 v13, s34, v13
    v_cos_f32 v8, v8
    v_cos_f32 v9, v9
    v_pk_mul_f32 v[12:13], v[12:13], v[16:17] op_sel:[0,0] op_sel_hi:[1,0]
    v_pk_add_f32 v[10:11], v[8:9], v[8:9]
    v_fract_f32 v12, v12
    v_fract_f32 v13, v13
    v_pk_fma_f32 v[10:11], v[10:11], v[8:9], v[18:19] op_sel:[0,0,0] op_sel_hi:[1,1,0]
    v_cos_f32 v12, v12
    v_cos_f32 v13, v13
    v_cvt_pk_bf16_f32 v34, v8, v10
    v_cvt_pk_bf16_f32 v38, v9, v11
    v_cvt_pk_bf16_f32 v4, v12, v13
    s_waitcnt lgkmcnt(0)
    v_lshl_or_b32 v35, v4, 16, v35
    v_and_or_b32 v39, v4, v19, v39
    s_waitcnt vmcnt(4)
    ds_write_b128 v2, v[32:35] offset:2048
    ds_write_b128 v2, v[36:39] offset:3072
    s_setprio 2
    v_readlane_b32 s26, v20, 4
    v_lshrrev_b32 v4, 13, v56
    v_lshrrev_b32 v5, 13, v57
    s_sub_u32 s27, s26, 2
    v_cmp_gt_u32 s[52:53], s26, v21
    v_cmp_gt_i32 s[54:55], s27, v21
    s_or_b64 exec, s[52:53], 1
    buffer_load_dwordx2 v[32:33], v4, s[4:7], 0 idxen
    s_or_b64 exec, s[54:55], 1
    buffer_load_dwordx2 v[36:37], v5, s[4:7], 0 idxen
    s_mov_b64 exec, -1
    v_and_b32 v14, 0x1ffc, v52
    v_and_b32 v15, 0x1ffc, v53
    v_add_u32 v4, 256, v1
    v_add_u32 v5, 320, v1
    s_mov_b64 exec, s[44:45]
    ds_wrxchg_rtn_b32 v43, v14, v4 offset:0
    s_mov_b64 exec, s[46:47]
    ds_wrxchg_rtn_b32 v47, v15, v5 offset:0
    s_mov_b64 exec, -1
    v_lshlrev_b32 v6, 16, v104
    v_and_b32 v7, s34, v104
    v_pk_mul_f32 v[12:13], v[6:7], v[16:17] op_sel:[0,1] op_sel_hi:[1,1]
    v_pk_mul_f32 v[8:9], v[6:7], v[16:17] op_sel:[0,0] op_sel_hi:[1,0]
    v_cvt_pk_bf16_f32 v13, v12, v13
    v_fract_f32 v8, v8
    v_fract_f32 v9, v9
    v_lshlrev_b32 v12, 16, v13
    v_and_b32 v13, s34, v13
    v_cos_f32 v8, v8
    v_cos_f32 v9, v9
    v_pk_mul_f32 v[12:13], v[12:13], v[16:17] op_sel:[0,0] op_sel_hi:[1,0]
    v_pk_add_f32 v[10:11], v[8:9], v[8:9]
    v_fract_f32 v12, v12
    v_fract_f32 v13, v13
    v_pk_fma_f32 v[10:11], v[10:11], v[8:9], v[18:19] op_sel:[0,0,0] op_sel_hi:[1,1,0]
    v_cos_f32 v12, v12
    v_cos_f32 v13, v13
    v_cvt_pk_bf16_f32 v42, v8, v10
    v_cvt_pk_bf16_f32 v46, v9, v11
    v_cvt_pk_bf16_f32 v4, v12, v13
    s_waitcnt lgkmcnt(0)
    v_lshl_or_b32 v43, v4, 16, v43
    v_and_or_b32 v47, v4, v19, v47
    s_waitcnt vmcnt(4)
    ds_write_b128 v2, v[40:43] offset:4096
    ds_write_b128 v2, v[44:47] offset:5120
    s_setprio 1
    v_readlane_b32 s26, v20, 5
    v_lshrrev_b32 v4, 13, v58
    v_lshrrev_b32 v5, 13, v59
    s_sub_u32 s27, s26, 2
    v_cmp_gt_u32 s[56:57], s26, v21
    v_cmp_gt_i32 s[58:59], s27, v21
    s_or_b64 exec, s[56:57], 1
    buffer_load_dwordx2 v[40:41], v4, s[4:7], 0 idxen
    s_or_b64 exec, s[58:59], 1
    buffer_load_dwordx2 v[44:45], v5, s[4:7], 0 idxen
    s_mov_b64 exec, -1
    v_and_b32 v14, 0x1ffc, v54
    v_and_b32 v15, 0x1ffc, v55
    v_add_u32 v4, 384, v1
    v_add_u32 v5, 448, v1
    s_mov_b64 exec, s[48:49]
    ds_wrxchg_rtn_b32 v27, v14, v4 offset:0
    s_mov_b64 exec, s[50:51]
    ds_wrxchg_rtn_b32 v31, v15, v5 offset:0
    s_mov_b64 exec, -1
    v_lshlrev_b32 v6, 16, v105
    v_and_b32 v7, s34, v105
    v_pk_mul_f32 v[12:13], v[6:7], v[16:17] op_sel:[0,1] op_sel_hi:[1,1]
    v_pk_mul_f32 v[8:9], v[6:7], v[16:17] op_sel:[0,0] op_sel_hi:[1,0]
    v_cvt_pk_bf16_f32 v13, v12, v13
    v_fract_f32 v8, v8
    v_fract_f32 v9, v9
    v_lshlrev_b32 v12, 16, v13
    v_and_b32 v13, s34, v13
    v_cos_f32 v8, v8
    v_cos_f32 v9, v9
    v_pk_mul_f32 v[12:13], v[12:13], v[16:17] op_sel:[0,0] op_sel_hi:[1,0]
    v_pk_add_f32 v[10:11], v[8:9], v[8:9]
    v_fract_f32 v12, v12
    v_fract_f32 v13, v13
    v_pk_fma_f32 v[10:11], v[10:11], v[8:9], v[18:19] op_sel:[0,0,0] op_sel_hi:[1,1,0]
    v_cos_f32 v12, v12
    v_cos_f32 v13, v13
    v_cvt_pk_bf16_f32 v26, v8, v10
    v_cvt_pk_bf16_f32 v30, v9, v11
    v_cvt_pk_bf16_f32 v4, v12, v13
    s_waitcnt lgkmcnt(0)
    v_lshl_or_b32 v27, v4, 16, v27
    v_and_or_b32 v31, v4, v19, v31
    s_waitcnt vmcnt(4)
    ds_write_b128 v2, v[24:27] offset:6144
    ds_write_b128 v2, v[28:31] offset:7168
    s_setprio 0
    v_readlane_b32 s26, v20, 6
    v_lshrrev_b32 v4, 13, v60
    v_lshrrev_b32 v5, 13, v61
    s_sub_u32 s27, s26, 2
    v_cmp_gt_u32 s[60:61], s26, v21
    v_cmp_gt_i32 s[62:63], s27, v21
    s_or_b64 exec, s[60:61], 1
    buffer_load_dwordx2 v[24:25], v4, s[4:7], 0 idxen
    s_or_b64 exec, s[62:63], 1
    buffer_load_dwordx2 v[28:29], v5, s[4:7], 0 idxen
    s_mov_b64 exec, -1
    v_and_b32 v14, 0x1ffc, v56
    v_and_b32 v15, 0x1ffc, v57
    v_add_u32 v4, 512, v1
    v_add_u32 v5, 576, v1
    s_mov_b64 exec, s[52:53]
    ds_wrxchg_rtn_b32 v35, v14, v4 offset:0
    s_mov_b64 exec, s[54:55]
    ds_wrxchg_rtn_b32 v39, v15, v5 offset:0
    s_mov_b64 exec, -1
    v_lshlrev_b32 v6, 16, v106
    v_and_b32 v7, s34, v106
    v_pk_mul_f32 v[12:13], v[6:7], v[16:17] op_sel:[0,1] op_sel_hi:[1,1]
    v_pk_mul_f32 v[8:9], v[6:7], v[16:17] op_sel:[0,0] op_sel_hi:[1,0]
    v_cvt_pk_bf16_f32 v13, v12, v13
    v_fract_f32 v8, v8
    v_fract_f32 v9, v9
    v_lshlrev_b32 v12, 16, v13
    v_and_b32 v13, s34, v13
    v_cos_f32 v8, v8
    v_cos_f32 v9, v9
    v_pk_mul_f32 v[12:13], v[12:13], v[16:17] op_sel:[0,0] op_sel_hi:[1,0]
    v_pk_add_f32 v[10:11], v[8:9], v[8:9]
    v_fract_f32 v12, v12
    v_fract_f32 v13, v13
    v_pk_fma_f32 v[10:11], v[10:11], v[8:9], v[18:19] op_sel:[0,0,0] op_sel_hi:[1,1,0]
    v_cos_f32 v12, v12
    v_cos_f32 v13, v13
    v_cvt_pk_bf16_f32 v34, v8, v10
    v_cvt_pk_bf16_f32 v38, v9, v11
    v_cvt_pk_bf16_f32 v4, v12, v13
    s_waitcnt lgkmcnt(0)
    v_lshl_or_b32 v35, v4, 16, v35
    v_and_or_b32 v39, v4, v19, v39
    s_waitcnt vmcnt(4)
    ds_write_b128 v2, v[32:35] offset:8192
    ds_write_b128 v2, v[36:39] offset:9216
    s_waitcnt lgkmcnt(0)
    s_barrier
    s_setprio 2
    v_readlane_b32 s26, v20, 7
    v_lshrrev_b32 v4, 13, v62
    v_lshrrev_b32 v5, 13, v63
    s_sub_u32 s27, s26, 2
    v_cmp_gt_u32 s[64:65], s26, v21
    v_cmp_gt_i32 s[66:67], s27, v21
    s_or_b64 exec, s[64:65], 1
    buffer_load_dwordx2 v[48:49], v4, s[4:7], 0 idxen
    s_or_b64 exec, s[66:67], 1
    buffer_load_dwordx2 v[52:53], v5, s[4:7], 0 idxen
    s_mov_b64 exec, -1
    v_and_b32 v14, 0x1ffc, v58
    v_and_b32 v15, 0x1ffc, v59
    v_add_u32 v4, 640, v1
    v_add_u32 v5, 704, v1
    s_mov_b64 exec, s[56:57]
    ds_wrxchg_rtn_b32 v43, v14, v4 offset:6400
    s_mov_b64 exec, s[58:59]
    ds_wrxchg_rtn_b32 v47, v15, v5 offset:6400
    s_mov_b64 exec, -1
    v_lshlrev_b32 v6, 16, v107
    v_and_b32 v7, s34, v107
    v_pk_mul_f32 v[12:13], v[6:7], v[16:17] op_sel:[0,1] op_sel_hi:[1,1]
    v_pk_mul_f32 v[8:9], v[6:7], v[16:17] op_sel:[0,0] op_sel_hi:[1,0]
    v_cvt_pk_bf16_f32 v13, v12, v13
    v_fract_f32 v8, v8
    v_fract_f32 v9, v9
    v_lshlrev_b32 v12, 16, v13
    v_and_b32 v13, s34, v13
    v_cos_f32 v8, v8
    v_cos_f32 v9, v9
    v_pk_mul_f32 v[12:13], v[12:13], v[16:17] op_sel:[0,0] op_sel_hi:[1,0]
    v_pk_add_f32 v[10:11], v[8:9], v[8:9]
    v_fract_f32 v12, v12
    v_fract_f32 v13, v13
    v_pk_fma_f32 v[10:11], v[10:11], v[8:9], v[18:19] op_sel:[0,0,0] op_sel_hi:[1,1,0]
    v_cos_f32 v12, v12
    v_cos_f32 v13, v13
    v_cvt_pk_bf16_f32 v42, v8, v10
    v_cvt_pk_bf16_f32 v46, v9, v11
    v_cvt_pk_bf16_f32 v4, v12, v13
    s_waitcnt lgkmcnt(0)
    v_lshl_or_b32 v43, v4, 16, v43
    v_and_or_b32 v47, v4, v19, v47
    s_waitcnt vmcnt(4)
    ds_write_b128 v2, v[40:43] offset:10240
    ds_write_b128 v2, v[44:47] offset:11264
    s_setprio 2
    v_readlane_b32 s26, v20, 8
    v_lshrrev_b32 v4, 13, v64
    v_lshrrev_b32 v5, 13, v65
    s_sub_u32 s27, s26, 2
    v_cmp_gt_u32 s[68:69], s26, v21
    v_cmp_gt_i32 s[70:71], s27, v21
    s_or_b64 exec, s[68:69], 1
    buffer_load_dwordx2 v[32:33], v4, s[4:7], 0 idxen
    s_or_b64 exec, s[70:71], 1
    buffer_load_dwordx2 v[36:37], v5, s[4:7], 0 idxen
    s_mov_b64 exec, -1
    v_and_b32 v14, 0x1ffc, v60
    v_and_b32 v15, 0x1ffc, v61
    v_add_u32 v4, 768, v1
    v_add_u32 v5, 832, v1
    s_mov_b64 exec, s[60:61]
    ds_wrxchg_rtn_b32 v27, v14, v4 offset:6400
    s_mov_b64 exec, s[62:63]
    ds_wrxchg_rtn_b32 v31, v15, v5 offset:6400
    s_mov_b64 exec, -1
    v_lshlrev_b32 v6, 16, v108
    v_and_b32 v7, s34, v108
    v_pk_mul_f32 v[12:13], v[6:7], v[16:17] op_sel:[0,1] op_sel_hi:[1,1]
    v_pk_mul_f32 v[8:9], v[6:7], v[16:17] op_sel:[0,0] op_sel_hi:[1,0]
    v_cvt_pk_bf16_f32 v13, v12, v13
    v_fract_f32 v8, v8
    v_fract_f32 v9, v9
    v_lshlrev_b32 v12, 16, v13
    v_and_b32 v13, s34, v13
    v_cos_f32 v8, v8
    v_cos_f32 v9, v9
    v_pk_mul_f32 v[12:13], v[12:13], v[16:17] op_sel:[0,0] op_sel_hi:[1,0]
    v_pk_add_f32 v[10:11], v[8:9], v[8:9]
    v_fract_f32 v12, v12
    v_fract_f32 v13, v13
    v_pk_fma_f32 v[10:11], v[10:11], v[8:9], v[18:19] op_sel:[0,0,0] op_sel_hi:[1,1,0]
    v_cos_f32 v12, v12
    v_cos_f32 v13, v13
    v_cvt_pk_bf16_f32 v26, v8, v10
    v_cvt_pk_bf16_f32 v30, v9, v11
    v_cvt_pk_bf16_f32 v4, v12, v13
    s_waitcnt lgkmcnt(0)
    v_lshl_or_b32 v27, v4, 16, v27
    v_and_or_b32 v31, v4, v19, v31
    s_waitcnt vmcnt(4)
    ds_write_b128 v2, v[24:27] offset:12288
    ds_write_b128 v2, v[28:31] offset:13312
    s_setprio 1
    v_readlane_b32 s26, v20, 9
    v_lshrrev_b32 v4, 13, v66
    v_lshrrev_b32 v5, 13, v67
    s_sub_u32 s27, s26, 2
    v_cmp_gt_u32 s[72:73], s26, v21
    v_cmp_gt_i32 s[74:75], s27, v21
    s_or_b64 exec, s[72:73], 1
    buffer_load_dwordx2 v[40:41], v4, s[4:7], 0 idxen
    s_or_b64 exec, s[74:75], 1
    buffer_load_dwordx2 v[44:45], v5, s[4:7], 0 idxen
    s_mov_b64 exec, -1
    v_and_b32 v14, 0x1ffc, v62
    v_and_b32 v15, 0x1ffc, v63
    v_add_u32 v4, 896, v1
    v_add_u32 v5, 960, v1
    s_mov_b64 exec, s[64:65]
    ds_wrxchg_rtn_b32 v51, v14, v4 offset:6400
    s_mov_b64 exec, s[66:67]
    ds_wrxchg_rtn_b32 v55, v15, v5 offset:6400
    s_mov_b64 exec, -1
    v_lshlrev_b32 v6, 16, v109
    v_and_b32 v7, s34, v109
    v_pk_mul_f32 v[12:13], v[6:7], v[16:17] op_sel:[0,1] op_sel_hi:[1,1]
    v_pk_mul_f32 v[8:9], v[6:7], v[16:17] op_sel:[0,0] op_sel_hi:[1,0]
    v_cvt_pk_bf16_f32 v13, v12, v13
    v_fract_f32 v8, v8
    v_fract_f32 v9, v9
    v_lshlrev_b32 v12, 16, v13
    v_and_b32 v13, s34, v13
    v_cos_f32 v8, v8
    v_cos_f32 v9, v9
    v_pk_mul_f32 v[12:13], v[12:13], v[16:17] op_sel:[0,0] op_sel_hi:[1,0]
    v_pk_add_f32 v[10:11], v[8:9], v[8:9]
    v_fract_f32 v12, v12
    v_fract_f32 v13, v13
    v_pk_fma_f32 v[10:11], v[10:11], v[8:9], v[18:19] op_sel:[0,0,0] op_sel_hi:[1,1,0]
    v_cos_f32 v12, v12
    v_cos_f32 v13, v13
    v_cvt_pk_bf16_f32 v50, v8, v10
    v_cvt_pk_bf16_f32 v54, v9, v11
    v_cvt_pk_bf16_f32 v4, v12, v13
    s_waitcnt lgkmcnt(0)
    v_lshl_or_b32 v51, v4, 16, v51
    v_and_or_b32 v55, v4, v19, v55
    s_waitcnt vmcnt(4)
    ds_write_b128 v2, v[48:51] offset:14336
    ds_write_b128 v2, v[52:55] offset:15360
    s_setprio 0
    v_readlane_b32 s26, v20, 10
    v_lshrrev_b32 v4, 13, v68
    v_lshrrev_b32 v5, 13, v69
    s_sub_u32 s27, s26, 2
    v_cmp_gt_u32 s[76:77], s26, v21
    v_cmp_gt_i32 s[78:79], s27, v21
    s_or_b64 exec, s[76:77], 1
    buffer_load_dwordx2 v[24:25], v4, s[4:7], 0 idxen
    s_or_b64 exec, s[78:79], 1
    buffer_load_dwordx2 v[28:29], v5, s[4:7], 0 idxen
    s_mov_b64 exec, -1
    v_and_b32 v14, 0x1ffc, v64
    v_and_b32 v15, 0x1ffc, v65
    v_add_u32 v4, 1024, v1
    v_add_u32 v5, 1088, v1
    s_mov_b64 exec, s[68:69]
    ds_wrxchg_rtn_b32 v35, v14, v4 offset:6400
    s_mov_b64 exec, s[70:71]
    ds_wrxchg_rtn_b32 v39, v15, v5 offset:6400
    s_mov_b64 exec, -1
    v_lshlrev_b32 v6, 16, v110
    v_and_b32 v7, s34, v110
    v_pk_mul_f32 v[12:13], v[6:7], v[16:17] op_sel:[0,1] op_sel_hi:[1,1]
    v_pk_mul_f32 v[8:9], v[6:7], v[16:17] op_sel:[0,0] op_sel_hi:[1,0]
    v_cvt_pk_bf16_f32 v13, v12, v13
    v_fract_f32 v8, v8
    v_fract_f32 v9, v9
    v_lshlrev_b32 v12, 16, v13
    v_and_b32 v13, s34, v13
    v_cos_f32 v8, v8
    v_cos_f32 v9, v9
    v_pk_mul_f32 v[12:13], v[12:13], v[16:17] op_sel:[0,0] op_sel_hi:[1,0]
    v_pk_add_f32 v[10:11], v[8:9], v[8:9]
    v_fract_f32 v12, v12
    v_fract_f32 v13, v13
    v_pk_fma_f32 v[10:11], v[10:11], v[8:9], v[18:19] op_sel:[0,0,0] op_sel_hi:[1,1,0]
    v_cos_f32 v12, v12
    v_cos_f32 v13, v13
    v_cvt_pk_bf16_f32 v34, v8, v10
    v_cvt_pk_bf16_f32 v38, v9, v11
    v_cvt_pk_bf16_f32 v4, v12, v13
    s_waitcnt lgkmcnt(0)
    v_lshl_or_b32 v35, v4, 16, v35
    v_and_or_b32 v39, v4, v19, v39
    s_waitcnt vmcnt(4)
    ds_write_b128 v2, v[32:35] offset:16384
    ds_write_b128 v2, v[36:39] offset:17408
    s_waitcnt lgkmcnt(0)
    s_barrier
    s_setprio 2
    v_readlane_b32 s26, v20, 11
    v_lshrrev_b32 v4, 13, v70
    v_lshrrev_b32 v5, 13, v71
    s_sub_u32 s27, s26, 2
    v_cmp_gt_u32 s[80:81], s26, v21
    v_cmp_gt_i32 s[82:83], s27, v21
    s_or_b64 exec, s[80:81], 1
    buffer_load_dwordx2 v[48:49], v4, s[4:7], 0 idxen
    s_or_b64 exec, s[82:83], 1
    buffer_load_dwordx2 v[52:53], v5, s[4:7], 0 idxen
    s_mov_b64 exec, -1
    v_and_b32 v14, 0x1ffc, v66
    v_and_b32 v15, 0x1ffc, v67
    v_add_u32 v4, 0, v1
    v_add_u32 v5, 64, v1
    s_mov_b64 exec, s[72:73]
    ds_wrxchg_rtn_b32 v43, v14, v4 offset:0
    s_mov_b64 exec, s[74:75]
    ds_wrxchg_rtn_b32 v47, v15, v5 offset:0
    s_mov_b64 exec, -1
    v_lshlrev_b32 v6, 16, v111
    v_and_b32 v7, s34, v111
    v_pk_mul_f32 v[12:13], v[6:7], v[16:17] op_sel:[0,1] op_sel_hi:[1,1]
    v_pk_mul_f32 v[8:9], v[6:7], v[16:17] op_sel:[0,0] op_sel_hi:[1,0]
    v_cvt_pk_bf16_f32 v13, v12, v13
    v_fract_f32 v8, v8
    v_fract_f32 v9, v9
    v_lshlrev_b32 v12, 16, v13
    v_and_b32 v13, s34, v13
    v_cos_f32 v8, v8
    v_cos_f32 v9, v9
    v_pk_mul_f32 v[12:13], v[12:13], v[16:17] op_sel:[0,0] op_sel_hi:[1,0]
    v_pk_add_f32 v[10:11], v[8:9], v[8:9]
    v_fract_f32 v12, v12
    v_fract_f32 v13, v13
    v_pk_fma_f32 v[10:11], v[10:11], v[8:9], v[18:19] op_sel:[0,0,0] op_sel_hi:[1,1,0]
    v_cos_f32 v12, v12
    v_cos_f32 v13, v13
    v_cvt_pk_bf16_f32 v42, v8, v10
    v_cvt_pk_bf16_f32 v46, v9, v11
    v_cvt_pk_bf16_f32 v4, v12, v13
    s_waitcnt lgkmcnt(0)
    v_lshl_or_b32 v43, v4, 16, v43
    v_and_or_b32 v47, v4, v19, v47
    s_waitcnt vmcnt(4)
    ds_write_b128 v2, v[40:43] offset:0
    ds_write_b128 v2, v[44:47] offset:1024
    s_setprio 2
    v_readlane_b32 s26, v20, 12
    v_lshrrev_b32 v4, 13, v72
    v_lshrrev_b32 v5, 13, v73
    s_sub_u32 s27, s26, 2
    v_cmp_gt_u32 s[36:37], s26, v21
    v_cmp_gt_i32 s[38:39], s27, v21
    s_or_b64 exec, s[36:37], 1
    buffer_load_dwordx2 v[56:57], v4, s[4:7], 0 idxen
    s_or_b64 exec, s[38:39], 1
    buffer_load_dwordx2 v[60:61], v5, s[4:7], 0 idxen
    s_mov_b64 exec, -1
    v_and_b32 v14, 0x1ffc, v68
    v_and_b32 v15, 0x1ffc, v69
    v_add_u32 v4, 128, v1
    v_add_u32 v5, 192, v1
    s_mov_b64 exec, s[76:77]
    ds_wrxchg_rtn_b32 v27, v14, v4 offset:0
    s_mov_b64 exec, s[78:79]
    ds_wrxchg_rtn_b32 v31, v15, v5 offset:0
    s_mov_b64 exec, -1
    v_lshlrev_b32 v6, 16, v112
    v_and_b32 v7, s34, v112
    v_pk_mul_f32 v[12:13], v[6:7], v[16:17] op_sel:[0,1] op_sel_hi:[1,1]
    v_pk_mul_f32 v[8:9], v[6:7], v[16:17] op_sel:[0,0] op_sel_hi:[1,0]
    v_cvt_pk_bf16_f32 v13, v12, v13
    v_fract_f32 v8, v8
    v_fract_f32 v9, v9
    v_lshlrev_b32 v12, 16, v13
    v_and_b32 v13, s34, v13
    v_cos_f32 v8, v8
    v_cos_f32 v9, v9
    v_pk_mul_f32 v[12:13], v[12:13], v[16:17] op_sel:[0,0] op_sel_hi:[1,0]
    v_pk_add_f32 v[10:11], v[8:9], v[8:9]
    v_fract_f32 v12, v12
    v_fract_f32 v13, v13
    v_pk_fma_f32 v[10:11], v[10:11], v[8:9], v[18:19] op_sel:[0,0,0] op_sel_hi:[1,1,0]
    v_cos_f32 v12, v12
    v_cos_f32 v13, v13
    v_cvt_pk_bf16_f32 v26, v8, v10
    v_cvt_pk_bf16_f32 v30, v9, v11
    v_cvt_pk_bf16_f32 v4, v12, v13
    s_waitcnt lgkmcnt(0)
    v_lshl_or_b32 v27, v4, 16, v27
    v_and_or_b32 v31, v4, v19, v31
    s_waitcnt vmcnt(4)
    ds_write_b128 v2, v[24:27] offset:2048
    ds_write_b128 v2, v[28:31] offset:3072
    s_setprio 2
    v_readlane_b32 s26, v20, 13
    v_lshrrev_b32 v4, 13, v74
    v_lshrrev_b32 v5, 13, v75
    s_sub_u32 s27, s26, 2
    v_cmp_gt_u32 s[40:41], s26, v21
    v_cmp_gt_i32 s[42:43], s27, v21
    s_or_b64 exec, s[40:41], 1
    buffer_load_dwordx2 v[32:33], v4, s[4:7], 0 idxen
    s_or_b64 exec, s[42:43], 1
    buffer_load_dwordx2 v[36:37], v5, s[4:7], 0 idxen
    s_mov_b64 exec, -1
    v_and_b32 v14, 0x1ffc, v70
    v_and_b32 v15, 0x1ffc, v71
    v_add_u32 v4, 256, v1
    v_add_u32 v5, 320, v1
    s_mov_b64 exec, s[80:81]
    ds_wrxchg_rtn_b32 v51, v14, v4 offset:0
    s_mov_b64 exec, s[82:83]
    ds_wrxchg_rtn_b32 v55, v15, v5 offset:0
    s_mov_b64 exec, -1
    v_lshlrev_b32 v6, 16, v113
    v_and_b32 v7, s34, v113
    v_pk_mul_f32 v[12:13], v[6:7], v[16:17] op_sel:[0,1] op_sel_hi:[1,1]
    v_pk_mul_f32 v[8:9], v[6:7], v[16:17] op_sel:[0,0] op_sel_hi:[1,0]
    v_cvt_pk_bf16_f32 v13, v12, v13
    v_fract_f32 v8, v8
    v_fract_f32 v9, v9
    v_lshlrev_b32 v12, 16, v13
    v_and_b32 v13, s34, v13
    v_cos_f32 v8, v8
    v_cos_f32 v9, v9
    v_pk_mul_f32 v[12:13], v[12:13], v[16:17] op_sel:[0,0] op_sel_hi:[1,0]
    v_pk_add_f32 v[10:11], v[8:9], v[8:9]
    v_fract_f32 v12, v12
    v_fract_f32 v13, v13
    v_pk_fma_f32 v[10:11], v[10:11], v[8:9], v[18:19] op_sel:[0,0,0] op_sel_hi:[1,1,0]
    v_cos_f32 v12, v12
    v_cos_f32 v13, v13
    v_cvt_pk_bf16_f32 v50, v8, v10
    v_cvt_pk_bf16_f32 v54, v9, v11
    v_cvt_pk_bf16_f32 v4, v12, v13
    s_waitcnt lgkmcnt(0)
    v_lshl_or_b32 v51, v4, 16, v51
    v_and_or_b32 v55, v4, v19, v55
    s_waitcnt vmcnt(4)
    ds_write_b128 v2, v[48:51] offset:4096
    ds_write_b128 v2, v[52:55] offset:5120
    s_setprio 1
    v_readlane_b32 s26, v20, 14
    v_lshrrev_b32 v4, 13, v76
    v_lshrrev_b32 v5, 13, v77
    s_sub_u32 s27, s26, 2
    v_cmp_gt_u32 s[44:45], s26, v21
    v_cmp_gt_i32 s[46:47], s27, v21
    s_or_b64 exec, s[44:45], 1
    buffer_load_dwordx2 v[40:41], v4, s[4:7], 0 idxen
    s_or_b64 exec, s[46:47], 1
    buffer_load_dwordx2 v[44:45], v5, s[4:7], 0 idxen
    s_mov_b64 exec, -1
    v_and_b32 v14, 0x1ffc, v72
    v_and_b32 v15, 0x1ffc, v73
    v_add_u32 v4, 384, v1
    v_add_u32 v5, 448, v1
    s_mov_b64 exec, s[36:37]
    ds_wrxchg_rtn_b32 v59, v14, v4 offset:0
    s_mov_b64 exec, s[38:39]
    ds_wrxchg_rtn_b32 v63, v15, v5 offset:0
    s_mov_b64 exec, -1
    v_lshlrev_b32 v6, 16, v114
    v_and_b32 v7, s34, v114
    v_pk_mul_f32 v[12:13], v[6:7], v[16:17] op_sel:[0,1] op_sel_hi:[1,1]
    v_pk_mul_f32 v[8:9], v[6:7], v[16:17] op_sel:[0,0] op_sel_hi:[1,0]
    v_cvt_pk_bf16_f32 v13, v12, v13
    v_fract_f32 v8, v8
    v_fract_f32 v9, v9
    v_lshlrev_b32 v12, 16, v13
    v_and_b32 v13, s34, v13
    v_cos_f32 v8, v8
    v_cos_f32 v9, v9
    v_pk_mul_f32 v[12:13], v[12:13], v[16:17] op_sel:[0,0] op_sel_hi:[1,0]
    v_pk_add_f32 v[10:11], v[8:9], v[8:9]
    v_fract_f32 v12, v12
    v_fract_f32 v13, v13
    v_pk_fma_f32 v[10:11], v[10:11], v[8:9], v[18:19] op_sel:[0,0,0] op_sel_hi:[1,1,0]
    v_cos_f32 v12, v12
    v_cos_f32 v13, v13
    v_cvt_pk_bf16_f32 v58, v8, v10
    v_cvt_pk_bf16_f32 v62, v9, v11
    v_cvt_pk_bf16_f32 v4, v12, v13
    s_waitcnt lgkmcnt(0)
    v_lshl_or_b32 v59, v4, 16, v59
    v_and_or_b32 v63, v4, v19, v63
    s_waitcnt vmcnt(4)
    ds_write_b128 v2, v[56:59] offset:6144
    ds_write_b128 v2, v[60:63] offset:7168
    s_setprio 0
    v_readlane_b32 s26, v20, 15
    v_lshrrev_b32 v4, 13, v78
    v_lshrrev_b32 v5, 13, v79
    s_sub_u32 s27, s26, 2
    v_cmp_gt_u32 s[48:49], s26, v21
    v_cmp_gt_i32 s[50:51], s27, v21
    s_or_b64 exec, s[48:49], 1
    buffer_load_dwordx2 v[24:25], v4, s[4:7], 0 idxen
    s_or_b64 exec, s[50:51], 1
    buffer_load_dwordx2 v[28:29], v5, s[4:7], 0 idxen
    s_mov_b64 exec, -1
    v_and_b32 v14, 0x1ffc, v74
    v_and_b32 v15, 0x1ffc, v75
    v_add_u32 v4, 512, v1
    v_add_u32 v5, 576, v1
    s_mov_b64 exec, s[40:41]
    ds_wrxchg_rtn_b32 v35, v14, v4 offset:0
    s_mov_b64 exec, s[42:43]
    ds_wrxchg_rtn_b32 v39, v15, v5 offset:0
    s_mov_b64 exec, -1
    v_lshlrev_b32 v6, 16, v115
    v_and_b32 v7, s34, v115
    v_pk_mul_f32 v[12:13], v[6:7], v[16:17] op_sel:[0,1] op_sel_hi:[1,1]
    v_pk_mul_f32 v[8:9], v[6:7], v[16:17] op_sel:[0,0] op_sel_hi:[1,0]
    v_cvt_pk_bf16_f32 v13, v12, v13
    v_fract_f32 v8, v8
    v_fract_f32 v9, v9
    v_lshlrev_b32 v12, 16, v13
    v_and_b32 v13, s34, v13
    v_cos_f32 v8, v8
    v_cos_f32 v9, v9
    v_pk_mul_f32 v[12:13], v[12:13], v[16:17] op_sel:[0,0] op_sel_hi:[1,0]
    v_pk_add_f32 v[10:11], v[8:9], v[8:9]
    v_fract_f32 v12, v12
    v_fract_f32 v13, v13
    v_pk_fma_f32 v[10:11], v[10:11], v[8:9], v[18:19] op_sel:[0,0,0] op_sel_hi:[1,1,0]
    v_cos_f32 v12, v12
    v_cos_f32 v13, v13
    v_cvt_pk_bf16_f32 v34, v8, v10
    v_cvt_pk_bf16_f32 v38, v9, v11
    v_cvt_pk_bf16_f32 v4, v12, v13
    s_waitcnt lgkmcnt(0)
    v_lshl_or_b32 v35, v4, 16, v35
    v_and_or_b32 v39, v4, v19, v39
    s_waitcnt vmcnt(4)
    ds_write_b128 v2, v[32:35] offset:8192
    ds_write_b128 v2, v[36:39] offset:9216
    s_waitcnt lgkmcnt(0)
    s_barrier
    s_setprio 2
    v_readlane_b32 s26, v20, 16
    v_lshrrev_b32 v4, 13, v80
    v_lshrrev_b32 v5, 13, v81
    s_sub_u32 s27, s26, 2
    v_cmp_gt_u32 s[52:53], s26, v21
    v_cmp_gt_i32 s[54:55], s27, v21
    s_or_b64 exec, s[52:53], 1
    buffer_load_dwordx2 v[48:49], v4, s[4:7], 0 idxen
    s_or_b64 exec, s[54:55], 1
    buffer_load_dwordx2 v[52:53], v5, s[4:7], 0 idxen
    s_mov_b64 exec, -1
    v_and_b32 v14, 0x1ffc, v76
    v_and_b32 v15, 0x1ffc, v77
    v_add_u32 v4, 640, v1
    v_add_u32 v5, 704, v1
    s_mov_b64 exec, s[44:45]
    ds_wrxchg_rtn_b32 v43, v14, v4 offset:6400
    s_mov_b64 exec, s[46:47]
    ds_wrxchg_rtn_b32 v47, v15, v5 offset:6400
    s_mov_b64 exec, -1
    v_lshlrev_b32 v6, 16, v116
    v_and_b32 v7, s34, v116
    v_pk_mul_f32 v[12:13], v[6:7], v[16:17] op_sel:[0,1] op_sel_hi:[1,1]
    v_pk_mul_f32 v[8:9], v[6:7], v[16:17] op_sel:[0,0] op_sel_hi:[1,0]
    v_cvt_pk_bf16_f32 v13, v12, v13
    v_fract_f32 v8, v8
    v_fract_f32 v9, v9
    v_lshlrev_b32 v12, 16, v13
    v_and_b32 v13, s34, v13
    v_cos_f32 v8, v8
    v_cos_f32 v9, v9
    v_pk_mul_f32 v[12:13], v[12:13], v[16:17] op_sel:[0,0] op_sel_hi:[1,0]
    v_pk_add_f32 v[10:11], v[8:9], v[8:9]
    v_fract_f32 v12, v12
    v_fract_f32 v13, v13
    v_pk_fma_f32 v[10:11], v[10:11], v[8:9], v[18:19] op_sel:[0,0,0] op_sel_hi:[1,1,0]
    v_cos_f32 v12, v12
    v_cos_f32 v13, v13
    v_cvt_pk_bf16_f32 v42, v8, v10
    v_cvt_pk_bf16_f32 v46, v9, v11
    v_cvt_pk_bf16_f32 v4, v12, v13
    s_waitcnt lgkmcnt(0)
    v_lshl_or_b32 v43, v4, 16, v43
    v_and_or_b32 v47, v4, v19, v47
    s_waitcnt vmcnt(4)
    ds_write_b128 v2, v[40:43] offset:10240
    ds_write_b128 v2, v[44:47] offset:11264
    s_setprio 2
    v_readlane_b32 s26, v20, 17
    v_lshrrev_b32 v4, 13, v82
    v_lshrrev_b32 v5, 13, v83
    s_sub_u32 s27, s26, 2
    v_cmp_gt_u32 s[56:57], s26, v21
    v_cmp_gt_i32 s[58:59], s27, v21
    s_or_b64 exec, s[56:57], 1
    buffer_load_dwordx2 v[64:65], v4, s[4:7], 0 idxen
    s_or_b64 exec, s[58:59], 1
    buffer_load_dwordx2 v[68:69], v5, s[4:7], 0 idxen
    s_mov_b64 exec, -1
    v_and_b32 v14, 0x1ffc, v78
    v_and_b32 v15, 0x1ffc, v79
    v_add_u32 v4, 768, v1
    v_add_u32 v5, 832, v1
    s_mov_b64 exec, s[48:49]
    ds_wrxchg_rtn_b32 v27, v14, v4 offset:6400
    s_mov_b64 exec, s[50:51]
    ds_wrxchg_rtn_b32 v31, v15, v5 offset:6400
    s_mov_b64 exec, -1
    v_lshlrev_b32 v6, 16, v117
    v_and_b32 v7, s34, v117
    v_pk_mul_f32 v[12:13], v[6:7], v[16:17] op_sel:[0,1] op_sel_hi:[1,1]
    v_pk_mul_f32 v[8:9], v[6:7], v[16:17] op_sel:[0,0] op_sel_hi:[1,0]
    v_cvt_pk_bf16_f32 v13, v12, v13
    v_fract_f32 v8, v8
    v_fract_f32 v9, v9
    v_lshlrev_b32 v12, 16, v13
    v_and_b32 v13, s34, v13
    v_cos_f32 v8, v8
    v_cos_f32 v9, v9
    v_pk_mul_f32 v[12:13], v[12:13], v[16:17] op_sel:[0,0] op_sel_hi:[1,0]
    v_pk_add_f32 v[10:11], v[8:9], v[8:9]
    v_fract_f32 v12, v12
    v_fract_f32 v13, v13
    v_pk_fma_f32 v[10:11], v[10:11], v[8:9], v[18:19] op_sel:[0,0,0] op_sel_hi:[1,1,0]
    v_cos_f32 v12, v12
    v_cos_f32 v13, v13
    v_cvt_pk_bf16_f32 v26, v8, v10
    v_cvt_pk_bf16_f32 v30, v9, v11
    v_cvt_pk_bf16_f32 v4, v12, v13
    s_waitcnt lgkmcnt(0)
    v_lshl_or_b32 v27, v4, 16, v27
    v_and_or_b32 v31, v4, v19, v31
    s_waitcnt vmcnt(4)
    ds_write_b128 v2, v[24:27] offset:12288
    ds_write_b128 v2, v[28:31] offset:13312
    s_setprio 1
    v_readlane_b32 s26, v20, 18
    v_lshrrev_b32 v4, 13, v84
    v_lshrrev_b32 v5, 13, v85
    s_sub_u32 s27, s26, 2
    v_cmp_gt_u32 s[60:61], s26, v21
    v_cmp_gt_i32 s[62:63], s27, v21
    s_or_b64 exec, s[60:61], 1
    buffer_load_dwordx2 v[56:57], v4, s[4:7], 0 idxen
    s_or_b64 exec, s[62:63], 1
    buffer_load_dwordx2 v[60:61], v5, s[4:7], 0 idxen
    s_mov_b64 exec, -1
    v_and_b32 v14, 0x1ffc, v80
    v_and_b32 v15, 0x1ffc, v81
    v_add_u32 v4, 896, v1
    v_add_u32 v5, 960, v1
    s_mov_b64 exec, s[52:53]
    ds_wrxchg_rtn_b32 v51, v14, v4 offset:6400
    s_mov_b64 exec, s[54:55]
    ds_wrxchg_rtn_b32 v55, v15, v5 offset:6400
    s_mov_b64 exec, -1
    v_lshlrev_b32 v6, 16, v118
    v_and_b32 v7, s34, v118
    v_pk_mul_f32 v[12:13], v[6:7], v[16:17] op_sel:[0,1] op_sel_hi:[1,1]
    v_pk_mul_f32 v[8:9], v[6:7], v[16:17] op_sel:[0,0] op_sel_hi:[1,0]
    v_cvt_pk_bf16_f32 v13, v12, v13
    v_fract_f32 v8, v8
    v_fract_f32 v9, v9
    v_lshlrev_b32 v12, 16, v13
    v_and_b32 v13, s34, v13
    v_cos_f32 v8, v8
    v_cos_f32 v9, v9
    v_pk_mul_f32 v[12:13], v[12:13], v[16:17] op_sel:[0,0] op_sel_hi:[1,0]
    v_pk_add_f32 v[10:11], v[8:9], v[8:9]
    v_fract_f32 v12, v12
    v_fract_f32 v13, v13
    v_pk_fma_f32 v[10:11], v[10:11], v[8:9], v[18:19] op_sel:[0,0,0] op_sel_hi:[1,1,0]
    v_cos_f32 v12, v12
    v_cos_f32 v13, v13
    v_cvt_pk_bf16_f32 v50, v8, v10
    v_cvt_pk_bf16_f32 v54, v9, v11
    v_cvt_pk_bf16_f32 v4, v12, v13
    s_waitcnt lgkmcnt(0)
    v_lshl_or_b32 v51, v4, 16, v51
    v_and_or_b32 v55, v4, v19, v55
    s_waitcnt vmcnt(4)
    ds_write_b128 v2, v[48:51] offset:14336
    ds_write_b128 v2, v[52:55] offset:15360
    s_setprio 0
    v_readlane_b32 s26, v20, 19
    v_lshrrev_b32 v4, 13, v86
    v_lshrrev_b32 v5, 13, v87
    s_sub_u32 s27, s26, 2
    v_cmp_gt_u32 s[64:65], s26, v21
    v_cmp_gt_i32 s[66:67], s27, v21
    s_or_b64 exec, s[64:65], 1
    buffer_load_dwordx2 v[32:33], v4, s[4:7], 0 idxen
    s_or_b64 exec, s[66:67], 1
    buffer_load_dwordx2 v[36:37], v5, s[4:7], 0 idxen
    s_mov_b64 exec, -1
    v_and_b32 v14, 0x1ffc, v82
    v_and_b32 v15, 0x1ffc, v83
    v_add_u32 v4, 1024, v1
    v_add_u32 v5, 1088, v1
    s_mov_b64 exec, s[56:57]
    ds_wrxchg_rtn_b32 v67, v14, v4 offset:6400
    s_mov_b64 exec, s[58:59]
    ds_wrxchg_rtn_b32 v71, v15, v5 offset:6400
    s_mov_b64 exec, -1
    v_lshlrev_b32 v6, 16, v119
    v_and_b32 v7, s34, v119
    v_pk_mul_f32 v[12:13], v[6:7], v[16:17] op_sel:[0,1] op_sel_hi:[1,1]
    v_pk_mul_f32 v[8:9], v[6:7], v[16:17] op_sel:[0,0] op_sel_hi:[1,0]
    v_cvt_pk_bf16_f32 v13, v12, v13
    v_fract_f32 v8, v8
    v_fract_f32 v9, v9
    v_lshlrev_b32 v12, 16, v13
    v_and_b32 v13, s34, v13
    v_cos_f32 v8, v8
    v_cos_f32 v9, v9
    v_pk_mul_f32 v[12:13], v[12:13], v[16:17] op_sel:[0,0] op_sel_hi:[1,0]
    v_pk_add_f32 v[10:11], v[8:9], v[8:9]
    v_fract_f32 v12, v12
    v_fract_f32 v13, v13
    v_pk_fma_f32 v[10:11], v[10:11], v[8:9], v[18:19] op_sel:[0,0,0] op_sel_hi:[1,1,0]
    v_cos_f32 v12, v12
    v_cos_f32 v13, v13
    v_cvt_pk_bf16_f32 v66, v8, v10
    v_cvt_pk_bf16_f32 v70, v9, v11
    v_cvt_pk_bf16_f32 v4, v12, v13
    s_waitcnt lgkmcnt(0)
    v_lshl_or_b32 v67, v4, 16, v67
    v_and_or_b32 v71, v4, v19, v71
    s_waitcnt vmcnt(4)
    ds_write_b128 v2, v[64:67] offset:16384
    ds_write_b128 v2, v[68:71] offset:17408
    s_waitcnt lgkmcnt(0)
    s_barrier
    s_setprio 2
    v_readlane_b32 s26, v20, 20
    v_lshrrev_b32 v4, 13, v88
    v_lshrrev_b32 v5, 13, v89
    s_sub_u32 s27, s26, 2
    v_cmp_gt_u32 s[68:69], s26, v21
    v_cmp_gt_i32 s[70:71], s27, v21
    s_or_b64 exec, s[68:69], 1
    buffer_load_dwordx2 v[40:41], v4, s[4:7], 0 idxen
    s_or_b64 exec, s[70:71], 1
    buffer_load_dwordx2 v[44:45], v5, s[4:7], 0 idxen
    s_mov_b64 exec, -1
    v_and_b32 v14, 0x1ffc, v84
    v_and_b32 v15, 0x1ffc, v85
    v_add_u32 v4, 0, v1
    v_add_u32 v5, 64, v1
    s_mov_b64 exec, s[60:61]
    ds_wrxchg_rtn_b32 v59, v14, v4 offset:0
    s_mov_b64 exec, s[62:63]
    ds_wrxchg_rtn_b32 v63, v15, v5 offset:0
    s_mov_b64 exec, -1
    v_lshlrev_b32 v6, 16, v120
    v_and_b32 v7, s34, v120
    v_pk_mul_f32 v[12:13], v[6:7], v[16:17] op_sel:[0,1] op_sel_hi:[1,1]
    v_pk_mul_f32 v[8:9], v[6:7], v[16:17] op_sel:[0,0] op_sel_hi:[1,0]
    v_cvt_pk_bf16_f32 v13, v12, v13
    v_fract_f32 v8, v8
    v_fract_f32 v9, v9
    v_lshlrev_b32 v12, 16, v13
    v_and_b32 v13, s34, v13
    v_cos_f32 v8, v8
    v_cos_f32 v9, v9
    v_pk_mul_f32 v[12:13], v[12:13], v[16:17] op_sel:[0,0] op_sel_hi:[1,0]
    v_pk_add_f32 v[10:11], v[8:9], v[8:9]
    v_fract_f32 v12, v12
    v_fract_f32 v13, v13
    v_pk_fma_f32 v[10:11], v[10:11], v[8:9], v[18:19] op_sel:[0,0,0] op_sel_hi:[1,1,0]
    v_cos_f32 v12, v12
    v_cos_f32 v13, v13
    v_cvt_pk_bf16_f32 v58, v8, v10
    v_cvt_pk_bf16_f32 v62, v9, v11
    v_cvt_pk_bf16_f32 v4, v12, v13
    s_waitcnt lgkmcnt(0)
    v_lshl_or_b32 v59, v4, 16, v59
    v_and_or_b32 v63, v4, v19, v63
    s_waitcnt vmcnt(4)
    ds_write_b128 v2, v[56:59] offset:0
    ds_write_b128 v2, v[60:63] offset:1024
    s_setprio 2
    v_readlane_b32 s26, v20, 21
    v_lshrrev_b32 v4, 13, v90
    v_lshrrev_b32 v5, 13, v91
    s_sub_u32 s27, s26, 2
    v_cmp_gt_u32 s[72:73], s26, v21
    v_cmp_gt_i32 s[74:75], s27, v21
    s_or_b64 exec, s[72:73], 1
    buffer_load_dwordx2 v[24:25], v4, s[4:7], 0 idxen
    s_or_b64 exec, s[74:75], 1
    buffer_load_dwordx2 v[28:29], v5, s[4:7], 0 idxen
    s_mov_b64 exec, -1
    v_and_b32 v14, 0x1ffc, v86
    v_and_b32 v15, 0x1ffc, v87
    v_add_u32 v4, 128, v1
    v_add_u32 v5, 192, v1
    s_mov_b64 exec, s[64:65]
    ds_wrxchg_rtn_b32 v35, v14, v4 offset:0
    s_mov_b64 exec, s[66:67]
    ds_wrxchg_rtn_b32 v39, v15, v5 offset:0
    s_mov_b64 exec, -1
    v_lshlrev_b32 v6, 16, v121
    v_and_b32 v7, s34, v121
    v_pk_mul_f32 v[12:13], v[6:7], v[16:17] op_sel:[0,1] op_sel_hi:[1,1]
    v_pk_mul_f32 v[8:9], v[6:7], v[16:17] op_sel:[0,0] op_sel_hi:[1,0]
    v_cvt_pk_bf16_f32 v13, v12, v13
    v_fract_f32 v8, v8
    v_fract_f32 v9, v9
    v_lshlrev_b32 v12, 16, v13
    v_and_b32 v13, s34, v13
    v_cos_f32 v8, v8
    v_cos_f32 v9, v9
    v_pk_mul_f32 v[12:13], v[12:13], v[16:17] op_sel:[0,0] op_sel_hi:[1,0]
    v_pk_add_f32 v[10:11], v[8:9], v[8:9]
    v_fract_f32 v12, v12
    v_fract_f32 v13, v13
    v_pk_fma_f32 v[10:11], v[10:11], v[8:9], v[18:19] op_sel:[0,0,0] op_sel_hi:[1,1,0]
    v_cos_f32 v12, v12
    v_cos_f32 v13, v13
    v_cvt_pk_bf16_f32 v34, v8, v10
    v_cvt_pk_bf16_f32 v38, v9, v11
    v_cvt_pk_bf16_f32 v4, v12, v13
    s_waitcnt lgkmcnt(0)
    v_lshl_or_b32 v35, v4, 16, v35
    v_and_or_b32 v39, v4, v19, v39
    s_waitcnt vmcnt(4)
    ds_write_b128 v2, v[32:35] offset:2048
    ds_write_b128 v2, v[36:39] offset:3072
    s_setprio 2
    v_readlane_b32 s26, v20, 22
    v_lshrrev_b32 v4, 13, v92
    v_lshrrev_b32 v5, 13, v93
    s_sub_u32 s27, s26, 2
    v_cmp_gt_u32 s[76:77], s26, v21
    v_cmp_gt_i32 s[78:79], s27, v21
    s_or_b64 exec, s[76:77], 1
    buffer_load_dwordx2 v[72:73], v4, s[4:7], 0 idxen
    s_or_b64 exec, s[78:79], 1
    buffer_load_dwordx2 v[76:77], v5, s[4:7], 0 idxen
    s_mov_b64 exec, -1
    v_and_b32 v14, 0x1ffc, v88
    v_and_b32 v15, 0x1ffc, v89
    v_add_u32 v4, 256, v1
    v_add_u32 v5, 320, v1
    s_mov_b64 exec, s[68:69]
    ds_wrxchg_rtn_b32 v43, v14, v4 offset:0
    s_mov_b64 exec, s[70:71]
    ds_wrxchg_rtn_b32 v47, v15, v5 offset:0
    s_mov_b64 exec, -1
    v_lshlrev_b32 v6, 16, v122
    v_and_b32 v7, s34, v122
    v_pk_mul_f32 v[12:13], v[6:7], v[16:17] op_sel:[0,1] op_sel_hi:[1,1]
    v_pk_mul_f32 v[8:9], v[6:7], v[16:17] op_sel:[0,0] op_sel_hi:[1,0]
    v_cvt_pk_bf16_f32 v13, v12, v13
    v_fract_f32 v8, v8
    v_fract_f32 v9, v9
    v_lshlrev_b32 v12, 16, v13
    v_and_b32 v13, s34, v13
    v_cos_f32 v8, v8
    v_cos_f32 v9, v9
    v_pk_mul_f32 v[12:13], v[12:13], v[16:17] op_sel:[0,0] op_sel_hi:[1,0]
    v_pk_add_f32 v[10:11], v[8:9], v[8:9]
    v_fract_f32 v12, v12
    v_fract_f32 v13, v13
    v_pk_fma_f32 v[10:11], v[10:11], v[8:9], v[18:19] op_sel:[0,0,0] op_sel_hi:[1,1,0]
    v_cos_f32 v12, v12
    v_cos_f32 v13, v13
    v_cvt_pk_bf16_f32 v42, v8, v10
    v_cvt_pk_bf16_f32 v46, v9, v11
    v_cvt_pk_bf16_f32 v4, v12, v13
    s_waitcnt lgkmcnt(0)
    v_lshl_or_b32 v43, v4, 16, v43
    v_and_or_b32 v47, v4, v19, v47
    s_waitcnt vmcnt(4)
    ds_write_b128 v2, v[40:43] offset:4096
    ds_write_b128 v2, v[44:47] offset:5120
    s_setprio 1
    v_readlane_b32 s26, v20, 23
    v_lshrrev_b32 v4, 13, v94
    v_lshrrev_b32 v5, 13, v95
    s_sub_u32 s27, s26, 2
    v_cmp_gt_u32 s[80:81], s26, v21
    v_cmp_gt_i32 s[82:83], s27, v21
    s_or_b64 exec, s[80:81], 1
    buffer_load_dwordx2 v[48:49], v4, s[4:7], 0 idxen
    s_or_b64 exec, s[82:83], 1
    buffer_load_dwordx2 v[52:53], v5, s[4:7], 0 idxen
    s_mov_b64 exec, -1
    v_and_b32 v14, 0x1ffc, v90
    v_and_b32 v15, 0x1ffc, v91
    v_add_u32 v4, 384, v1
    v_add_u32 v5, 448, v1
    s_mov_b64 exec, s[72:73]
    ds_wrxchg_rtn_b32 v27, v14, v4 offset:0
    s_mov_b64 exec, s[74:75]
    ds_wrxchg_rtn_b32 v31, v15, v5 offset:0
    s_mov_b64 exec, -1
    v_lshlrev_b32 v6, 16, v123
    v_and_b32 v7, s34, v123
    v_pk_mul_f32 v[12:13], v[6:7], v[16:17] op_sel:[0,1] op_sel_hi:[1,1]
    v_pk_mul_f32 v[8:9], v[6:7], v[16:17] op_sel:[0,0] op_sel_hi:[1,0]
    v_cvt_pk_bf16_f32 v13, v12, v13
    v_fract_f32 v8, v8
    v_fract_f32 v9, v9
    v_lshlrev_b32 v12, 16, v13
    v_and_b32 v13, s34, v13
    v_cos_f32 v8, v8
    v_cos_f32 v9, v9
    v_pk_mul_f32 v[12:13], v[12:13], v[16:17] op_sel:[0,0] op_sel_hi:[1,0]
    v_pk_add_f32 v[10:11], v[8:9], v[8:9]
    v_fract_f32 v12, v12
    v_fract_f32 v13, v13
    v_pk_fma_f32 v[10:11], v[10:11], v[8:9], v[18:19] op_sel:[0,0,0] op_sel_hi:[1,1,0]
    v_cos_f32 v12, v12
    v_cos_f32 v13, v13
    v_cvt_pk_bf16_f32 v26, v8, v10
    v_cvt_pk_bf16_f32 v30, v9, v11
    v_cvt_pk_bf16_f32 v4, v12, v13
    s_waitcnt lgkmcnt(0)
    v_lshl_or_b32 v27, v4, 16, v27
    v_and_or_b32 v31, v4, v19, v31
    s_waitcnt vmcnt(4)
    ds_write_b128 v2, v[24:27] offset:6144
    ds_write_b128 v2, v[28:31] offset:7168
    s_setprio 0
    v_readlane_b32 s26, v20, 24
    v_lshrrev_b32 v4, 13, v96
    v_lshrrev_b32 v5, 13, v97
    s_sub_u32 s27, s26, 2
    v_cmp_gt_u32 s[36:37], s26, v21
    v_cmp_gt_i32 s[38:39], s27, v21
    s_or_b64 exec, s[36:37], 1
    buffer_load_dwordx2 v[64:65], v4, s[4:7], 0 idxen
    s_or_b64 exec, s[38:39], 1
    buffer_load_dwordx2 v[68:69], v5, s[4:7], 0 idxen
    s_mov_b64 exec, -1
    v_and_b32 v14, 0x1ffc, v92
    v_and_b32 v15, 0x1ffc, v93
    v_add_u32 v4, 512, v1
    v_add_u32 v5, 576, v1
    s_mov_b64 exec, s[76:77]
    ds_wrxchg_rtn_b32 v75, v14, v4 offset:0
    s_mov_b64 exec, s[78:79]
    ds_wrxchg_rtn_b32 v79, v15, v5 offset:0
    s_mov_b64 exec, -1
    v_lshlrev_b32 v6, 16, v124
    v_and_b32 v7, s34, v124
    v_pk_mul_f32 v[12:13], v[6:7], v[16:17] op_sel:[0,1] op_sel_hi:[1,1]
    v_pk_mul_f32 v[8:9], v[6:7], v[16:17] op_sel:[0,0] op_sel_hi:[1,0]
    v_cvt_pk_bf16_f32 v13, v12, v13
    v_fract_f32 v8, v8
    v_fract_f32 v9, v9
    v_lshlrev_b32 v12, 16, v13
    v_and_b32 v13, s34, v13
    v_cos_f32 v8, v8
    v_cos_f32 v9, v9
    v_pk_mul_f32 v[12:13], v[12:13], v[16:17] op_sel:[0,0] op_sel_hi:[1,0]
    v_pk_add_f32 v[10:11], v[8:9], v[8:9]
    v_fract_f32 v12, v12
    v_fract_f32 v13, v13
    v_pk_fma_f32 v[10:11], v[10:11], v[8:9], v[18:19] op_sel:[0,0,0] op_sel_hi:[1,1,0]
    v_cos_f32 v12, v12
    v_cos_f32 v13, v13
    v_cvt_pk_bf16_f32 v74, v8, v10
    v_cvt_pk_bf16_f32 v78, v9, v11
    v_cvt_pk_bf16_f32 v4, v12, v13
    s_waitcnt lgkmcnt(0)
    v_lshl_or_b32 v75, v4, 16, v75
    v_and_or_b32 v79, v4, v19, v79
    s_waitcnt vmcnt(4)
    ds_write_b128 v2, v[72:75] offset:8192
    ds_write_b128 v2, v[76:79] offset:9216
    s_waitcnt lgkmcnt(0)
    s_barrier
    s_setprio 2
    v_readlane_b32 s26, v20, 25
    v_lshrrev_b32 v4, 13, v98
    v_lshrrev_b32 v5, 13, v99
    s_sub_u32 s27, s26, 2
    v_cmp_gt_u32 s[40:41], s26, v21
    v_cmp_gt_i32 s[42:43], s27, v21
    s_or_b64 exec, s[40:41], 1
    buffer_load_dwordx2 v[56:57], v4, s[4:7], 0 idxen
    s_or_b64 exec, s[42:43], 1
    buffer_load_dwordx2 v[60:61], v5, s[4:7], 0 idxen
    s_mov_b64 exec, -1
    v_and_b32 v14, 0x1ffc, v94
    v_and_b32 v15, 0x1ffc, v95
    v_add_u32 v4, 640, v1
    v_add_u32 v5, 704, v1
    s_mov_b64 exec, s[80:81]
    ds_wrxchg_rtn_b32 v51, v14, v4 offset:6400
    s_mov_b64 exec, s[82:83]
    ds_wrxchg_rtn_b32 v55, v15, v5 offset:6400
    s_mov_b64 exec, -1
    v_lshlrev_b32 v6, 16, v125
    v_and_b32 v7, s34, v125
    v_pk_mul_f32 v[12:13], v[6:7], v[16:17] op_sel:[0,1] op_sel_hi:[1,1]
    v_pk_mul_f32 v[8:9], v[6:7], v[16:17] op_sel:[0,0] op_sel_hi:[1,0]
    v_cvt_pk_bf16_f32 v13, v12, v13
    v_fract_f32 v8, v8
    v_fract_f32 v9, v9
    v_lshlrev_b32 v12, 16, v13
    v_and_b32 v13, s34, v13
    v_cos_f32 v8, v8
    v_cos_f32 v9, v9
    v_pk_mul_f32 v[12:13], v[12:13], v[16:17] op_sel:[0,0] op_sel_hi:[1,0]
    v_pk_add_f32 v[10:11], v[8:9], v[8:9]
    v_fract_f32 v12, v12
    v_fract_f32 v13, v13
    v_pk_fma_f32 v[10:11], v[10:11], v[8:9], v[18:19] op_sel:[0,0,0] op_sel_hi:[1,1,0]
    v_cos_f32 v12, v12
    v_cos_f32 v13, v13
    v_cvt_pk_bf16_f32 v50, v8, v10
    v_cvt_pk_bf16_f32 v54, v9, v11
    v_cvt_pk_bf16_f32 v4, v12, v13
    s_waitcnt lgkmcnt(0)
    v_lshl_or_b32 v51, v4, 16, v51
    v_and_or_b32 v55, v4, v19, v55
    s_waitcnt vmcnt(4)
    ds_write_b128 v2, v[48:51] offset:10240
    ds_write_b128 v2, v[52:55] offset:11264
    s_setprio 2
    v_readlane_b32 s26, v20, 26
    v_lshrrev_b32 v4, 13, v100
    v_lshrrev_b32 v5, 13, v101
    s_sub_u32 s27, s26, 2
    v_cmp_gt_u32 s[44:45], s26, v21
    v_cmp_gt_i32 s[46:47], s27, v21
    s_or_b64 exec, s[44:45], 1
    buffer_load_dwordx2 v[32:33], v4, s[4:7], 0 idxen
    s_or_b64 exec, s[46:47], 1
    buffer_load_dwordx2 v[36:37], v5, s[4:7], 0 idxen
    s_mov_b64 exec, -1
    v_and_b32 v14, 0x1ffc, v96
    v_and_b32 v15, 0x1ffc, v97
    v_add_u32 v4, 768, v1
    v_add_u32 v5, 832, v1
    s_mov_b64 exec, s[36:37]
    ds_wrxchg_rtn_b32 v67, v14, v4 offset:6400
    s_mov_b64 exec, s[38:39]
    ds_wrxchg_rtn_b32 v71, v15, v5 offset:6400
    s_mov_b64 exec, -1
    v_lshlrev_b32 v6, 16, v126
    v_and_b32 v7, s34, v126
    v_pk_mul_f32 v[12:13], v[6:7], v[16:17] op_sel:[0,1] op_sel_hi:[1,1]
    v_pk_mul_f32 v[8:9], v[6:7], v[16:17] op_sel:[0,0] op_sel_hi:[1,0]
    v_cvt_pk_bf16_f32 v13, v12, v13
    v_fract_f32 v8, v8
    v_fract_f32 v9, v9
    v_lshlrev_b32 v12, 16, v13
    v_and_b32 v13, s34, v13
    v_cos_f32 v8, v8
    v_cos_f32 v9, v9
    v_pk_mul_f32 v[12:13], v[12:13], v[16:17] op_sel:[0,0] op_sel_hi:[1,0]
    v_pk_add_f32 v[10:11], v[8:9], v[8:9]
    v_fract_f32 v12, v12
    v_fract_f32 v13, v13
    v_pk_fma_f32 v[10:11], v[10:11], v[8:9], v[18:19] op_sel:[0,0,0] op_sel_hi:[1,1,0]
    v_cos_f32 v12, v12
    v_cos_f32 v13, v13
    v_cvt_pk_bf16_f32 v66, v8, v10
    v_cvt_pk_bf16_f32 v70, v9, v11
    v_cvt_pk_bf16_f32 v4, v12, v13
    s_waitcnt lgkmcnt(0)
    v_lshl_or_b32 v67, v4, 16, v67
    v_and_or_b32 v71, v4, v19, v71
    s_waitcnt vmcnt(4)
    ds_write_b128 v2, v[64:67] offset:12288
    ds_write_b128 v2, v[68:71] offset:13312
    s_setprio 1
    v_and_b32 v14, 0x1ffc, v98
    v_and_b32 v15, 0x1ffc, v99
    v_add_u32 v4, 896, v1
    v_add_u32 v5, 960, v1
    s_mov_b64 exec, s[40:41]
    ds_wrxchg_rtn_b32 v59, v14, v4 offset:6400
    s_mov_b64 exec, s[42:43]
    ds_wrxchg_rtn_b32 v63, v15, v5 offset:6400
    s_mov_b64 exec, -1
    v_lshlrev_b32 v6, 16, v127
    v_and_b32 v7, s34, v127
    v_pk_mul_f32 v[12:13], v[6:7], v[16:17] op_sel:[0,1] op_sel_hi:[1,1]
    v_pk_mul_f32 v[8:9], v[6:7], v[16:17] op_sel:[0,0] op_sel_hi:[1,0]
    v_cvt_pk_bf16_f32 v13, v12, v13
    v_fract_f32 v8, v8
    v_fract_f32 v9, v9
    v_lshlrev_b32 v12, 16, v13
    v_and_b32 v13, s34, v13
    v_cos_f32 v8, v8
    v_cos_f32 v9, v9
    v_pk_mul_f32 v[12:13], v[12:13], v[16:17] op_sel:[0,0] op_sel_hi:[1,0]
    v_pk_add_f32 v[10:11], v[8:9], v[8:9]
    v_fract_f32 v12, v12
    v_fract_f32 v13, v13
    v_pk_fma_f32 v[10:11], v[10:11], v[8:9], v[18:19] op_sel:[0,0,0] op_sel_hi:[1,1,0]
    v_cos_f32 v12, v12
    v_cos_f32 v13, v13
    v_cvt_pk_bf16_f32 v58, v8, v10
    v_cvt_pk_bf16_f32 v62, v9, v11
    v_cvt_pk_bf16_f32 v4, v12, v13
    s_waitcnt lgkmcnt(0)
    v_lshl_or_b32 v59, v4, 16, v59
    v_and_or_b32 v63, v4, v19, v63
    s_waitcnt vmcnt(2)
    ds_write_b128 v2, v[56:59] offset:14336
    ds_write_b128 v2, v[60:63] offset:15360
    s_setprio 0
    v_and_b32 v14, 0x1ffc, v100
    v_and_b32 v15, 0x1ffc, v101
    v_add_u32 v4, 1024, v1
    v_add_u32 v5, 1088, v1
    s_mov_b64 exec, s[44:45]
    ds_wrxchg_rtn_b32 v35, v14, v4 offset:6400
    s_mov_b64 exec, s[46:47]
    ds_wrxchg_rtn_b32 v39, v15, v5 offset:6400
    s_mov_b64 exec, -1
    v_lshlrev_b32 v6, 16, v23
    v_and_b32 v7, s34, v23
    v_pk_mul_f32 v[12:13], v[6:7], v[16:17] op_sel:[0,1] op_sel_hi:[1,1]
    v_pk_mul_f32 v[8:9], v[6:7], v[16:17] op_sel:[0,0] op_sel_hi:[1,0]
    v_cvt_pk_bf16_f32 v13, v12, v13
    v_fract_f32 v8, v8
    v_fract_f32 v9, v9
    v_lshlrev_b32 v12, 16, v13
    v_and_b32 v13, s34, v13
    v_cos_f32 v8, v8
    v_cos_f32 v9, v9
    v_pk_mul_f32 v[12:13], v[12:13], v[16:17] op_sel:[0,0] op_sel_hi:[1,0]
    v_pk_add_f32 v[10:11], v[8:9], v[8:9]
    v_fract_f32 v12, v12
    v_fract_f32 v13, v13
    v_pk_fma_f32 v[10:11], v[10:11], v[8:9], v[18:19] op_sel:[0,0,0] op_sel_hi:[1,1,0]
    v_cos_f32 v12, v12
    v_cos_f32 v13, v13
    v_cvt_pk_bf16_f32 v34, v8, v10
    v_cvt_pk_bf16_f32 v38, v9, v11
    v_cvt_pk_bf16_f32 v4, v12, v13
    s_waitcnt lgkmcnt(0)
    v_lshl_or_b32 v35, v4, 16, v35
    v_and_or_b32 v39, v4, v19, v39
    s_waitcnt vmcnt(0)
    ds_write_b128 v2, v[32:35] offset:16384
    ds_write_b128 v2, v[36:39] offset:17408
    s_waitcnt lgkmcnt(0)
    s_barrier
    s_cmp_lg_u32 s23, 0
    s_cbranch_scc0 b_pdone
    s_barrier
    s_branch a_batch
b_pdone:
    s_endpgm
b_consumer:
    s_setprio 3
    v_subrev_u32 v3, 512, v0
    v_add_u32 v1, s25, v3
    v_lshlrev_b32 v3, 2, v3
    s_waitcnt lgkmcnt(0)
    v_readfirstlane_b32 s23, v31
    v_lshlrev_b32 v1, 1, v1
    buffer_load_ushort v16, v1, s[60:63], 0 offen offset:0
    buffer_load_ushort v17, v1, s[60:63], 0 offen offset:1024
    buffer_load_ushort v18, v1, s[60:63], 0 offen offset:2048
    buffer_load_ushort v19, v1, s[60:63], 0 offen offset:3072
    v_mov_b32 v4, 800
    v_mov_b32 v5, 800
    v_mov_b32 v6, 800
    v_mov_b32 v7, 800
    v_mov_b32 v8, 0
    v_mov_b32 v9, 0
    v_mov_b32 v10, 0
    v_mov_b32 v11, 800
    v_lshlrev_b32 v2, 2, v3
    v_cmp_gt_u32 vcc, 4608, v2
    s_barrier
    ds_write_b128 v2, v[4:7]
    s_mov_b64 exec, vcc
    ds_write_b128 v2, v[4:7] offset:8192
    s_mov_b64 exec, -1
    ds_write_b128 v8, v[8:11] offset:12800
    s_waitcnt lgkmcnt(0)
    s_barrier
    s_setprio 0
    s_load_dwordx8 s[8:15], s[0:1], 56
    s_waitcnt vmcnt(0)
    v_lshlrev_b32 v16, 16, v16
    v_lshlrev_b32 v17, 16, v17
    v_lshlrev_b32 v18, 16, v18
    v_lshlrev_b32 v19, 16, v19
    s_lshl_b32 s26, s64, 16
    s_and_b32 s27, s64, 0xffff0000
    v_subrev_f32 v24, s26, v16
    v_subrev_f32 v25, s27, v16
    v_cvt_pk_bf16_f32 v4, v24, v25
    v_lshlrev_b32 v24, 16, v4
    v_and_b32 v25, 0xffff0000, v4
    v_mul_f32 v24, v24, v24
    v_mul_f32 v25, v25, v25
    v_cvt_pk_bf16_f32 v4, v24, v25
    v_lshlrev_b32 v24, 16, v4
    v_and_b32 v25, 0xffff0000, v4
    v_mul_f32 v24, 0xc1200000, v24
    v_mul_f32 v25, 0xc1200000, v25
    v_cvt_pk_bf16_f32 v4, v24, v25
    v_lshlrev_b32 v24, 16, v4
    v_and_b32 v25, 0xffff0000, v4
    v_mul_f32 v24, 0x3fb8aa3b, v24
    v_mul_f32 v25, 0x3fb8aa3b, v25
    v_exp_f32 v24, v24
    v_exp_f32 v25, v25
    s_nop 0
    v_cvt_pk_bf16_f32 v4, v24, v25
    v_subrev_f32 v26, s26, v17
    v_subrev_f32 v27, s27, v17
    v_cvt_pk_bf16_f32 v8, v26, v27
    v_lshlrev_b32 v26, 16, v8
    v_and_b32 v27, 0xffff0000, v8
    v_mul_f32 v26, v26, v26
    v_mul_f32 v27, v27, v27
    v_cvt_pk_bf16_f32 v8, v26, v27
    v_lshlrev_b32 v26, 16, v8
    v_and_b32 v27, 0xffff0000, v8
    v_mul_f32 v26, 0xc1200000, v26
    v_mul_f32 v27, 0xc1200000, v27
    v_cvt_pk_bf16_f32 v8, v26, v27
    v_lshlrev_b32 v26, 16, v8
    v_and_b32 v27, 0xffff0000, v8
    v_mul_f32 v26, 0x3fb8aa3b, v26
    v_mul_f32 v27, 0x3fb8aa3b, v27
    v_exp_f32 v26, v26
    v_exp_f32 v27, v27
    s_nop 0
    v_cvt_pk_bf16_f32 v8, v26, v27
    v_subrev_f32 v24, s26, v18
    v_subrev_f32 v25, s27, v18
    v_cvt_pk_bf16_f32 v12, v24, v25
    v_lshlrev_b32 v24, 16, v12
    v_and_b32 v25, 0xffff0000, v12
    v_mul_f32 v24, v24, v24
    v_mul_f32 v25, v25, v25
    v_cvt_pk_bf16_f32 v12, v24, v25
    v_lshlrev_b32 v24, 16, v12
    v_and_b32 v25, 0xffff0000, v12
    v_mul_f32 v24, 0xc1200000, v24
    v_mul_f32 v25, 0xc1200000, v25
    v_cvt_pk_bf16_f32 v12, v24, v25
    v_lshlrev_b32 v24, 16, v12
    v_and_b32 v25, 0xffff0000, v12
    v_mul_f32 v24, 0x3fb8aa3b, v24
    v_mul_f32 v25, 0x3fb8aa3b, v25
    v_exp_f32 v24, v24
    v_exp_f32 v25, v25
    s_nop 0
    v_cvt_pk_bf16_f32 v12, v24, v25
    v_subrev_f32 v26, s26, v19
    v_subrev_f32 v27, s27, v19
    v_cvt_pk_bf16_f32 v120, v26, v27
    v_lshlrev_b32 v26, 16, v120
    v_and_b32 v27, 0xffff0000, v120
    v_mul_f32 v26, v26, v26
    v_mul_f32 v27, v27, v27
    v_cvt_pk_bf16_f32 v120, v26, v27
    v_lshlrev_b32 v26, 16, v120
    v_and_b32 v27, 0xffff0000, v120
    v_mul_f32 v26, 0xc1200000, v26
    v_mul_f32 v27, 0xc1200000, v27
    v_cvt_pk_bf16_f32 v120, v26, v27
    v_lshlrev_b32 v26, 16, v120
    v_and_b32 v27, 0xffff0000, v120
    v_mul_f32 v26, 0x3fb8aa3b, v26
    v_mul_f32 v27, 0x3fb8aa3b, v27
    v_exp_f32 v26, v26
    v_exp_f32 v27, v27
    s_nop 0
    v_cvt_pk_bf16_f32 v120, v26, v27
    s_lshl_b32 s26, s65, 16
    s_and_b32 s27, s65, 0xffff0000
    v_subrev_f32 v24, s26, v16
    v_subrev_f32 v25, s27, v16
    v_cvt_pk_bf16_f32 v5, v24, v25
    v_lshlrev_b32 v24, 16, v5
    v_and_b32 v25, 0xffff0000, v5
    v_mul_f32 v24, v24, v24
    v_mul_f32 v25, v25, v25
    v_cvt_pk_bf16_f32 v5, v24, v25
    v_lshlrev_b32 v24, 16, v5
    v_and_b32 v25, 0xffff0000, v5
    v_mul_f32 v24, 0xc1200000, v24
    v_mul_f32 v25, 0xc1200000, v25
    v_cvt_pk_bf16_f32 v5, v24, v25
    v_lshlrev_b32 v24, 16, v5
    v_and_b32 v25, 0xffff0000, v5
    v_mul_f32 v24, 0x3fb8aa3b, v24
    v_mul_f32 v25, 0x3fb8aa3b, v25
    v_exp_f32 v24, v24
    v_exp_f32 v25, v25
    s_nop 0
    v_cvt_pk_bf16_f32 v5, v24, v25
    v_subrev_f32 v26, s26, v17
    v_subrev_f32 v27, s27, v17
    v_cvt_pk_bf16_f32 v9, v26, v27
    v_lshlrev_b32 v26, 16, v9
    v_and_b32 v27, 0xffff0000, v9
    v_mul_f32 v26, v26, v26
    v_mul_f32 v27, v27, v27
    v_cvt_pk_bf16_f32 v9, v26, v27
    v_lshlrev_b32 v26, 16, v9
    v_and_b32 v27, 0xffff0000, v9
    v_mul_f32 v26, 0xc1200000, v26
    v_mul_f32 v27, 0xc1200000, v27
    v_cvt_pk_bf16_f32 v9, v26, v27
    v_lshlrev_b32 v26, 16, v9
    v_and_b32 v27, 0xffff0000, v9
    v_mul_f32 v26, 0x3fb8aa3b, v26
    v_mul_f32 v27, 0x3fb8aa3b, v27
    v_exp_f32 v26, v26
    v_exp_f32 v27, v27
    s_nop 0
    v_cvt_pk_bf16_f32 v9, v26, v27
    v_subrev_f32 v24, s26, v18
    v_subrev_f32 v25, s27, v18
    v_cvt_pk_bf16_f32 v13, v24, v25
    v_lshlrev_b32 v24, 16, v13
    v_and_b32 v25, 0xffff0000, v13
    v_mul_f32 v24, v24, v24
    v_mul_f32 v25, v25, v25
    v_cvt_pk_bf16_f32 v13, v24, v25
    v_lshlrev_b32 v24, 16, v13
    v_and_b32 v25, 0xffff0000, v13
    v_mul_f32 v24, 0xc1200000, v24
    v_mul_f32 v25, 0xc1200000, v25
    v_cvt_pk_bf16_f32 v13, v24, v25
    v_lshlrev_b32 v24, 16, v13
    v_and_b32 v25, 0xffff0000, v13
    v_mul_f32 v24, 0x3fb8aa3b, v24
    v_mul_f32 v25, 0x3fb8aa3b, v25
    v_exp_f32 v24, v24
    v_exp_f32 v25, v25
    s_nop 0
    v_cvt_pk_bf16_f32 v13, v24, v25
    v_subrev_f32 v26, s26, v19
    v_subrev_f32 v27, s27, v19
    v_cvt_pk_bf16_f32 v121, v26, v27
    v_lshlrev_b32 v26, 16, v121
    v_and_b32 v27, 0xffff0000, v121
    v_mul_f32 v26, v26, v26
    v_mul_f32 v27, v27, v27
    v_cvt_pk_bf16_f32 v121, v26, v27
    v_lshlrev_b32 v26, 16, v121
    v_and_b32 v27, 0xffff0000, v121
    v_mul_f32 v26, 0xc1200000, v26
    v_mul_f32 v27, 0xc1200000, v27
    v_cvt_pk_bf16_f32 v121, v26, v27
    v_lshlrev_b32 v26, 16, v121
    v_and_b32 v27, 0xffff0000, v121
    v_mul_f32 v26, 0x3fb8aa3b, v26
    v_mul_f32 v27, 0x3fb8aa3b, v27
    v_exp_f32 v26, v26
    v_exp_f32 v27, v27
    s_nop 0
    v_cvt_pk_bf16_f32 v121, v26, v27
    s_lshl_b32 s26, s66, 16
    s_and_b32 s27, s66, 0xffff0000
    v_subrev_f32 v24, s26, v16
    v_subrev_f32 v25, s27, v16
    v_cvt_pk_bf16_f32 v6, v24, v25
    v_lshlrev_b32 v24, 16, v6
    v_and_b32 v25, 0xffff0000, v6
    v_mul_f32 v24, v24, v24
    v_mul_f32 v25, v25, v25
    v_cvt_pk_bf16_f32 v6, v24, v25
    v_lshlrev_b32 v24, 16, v6
    v_and_b32 v25, 0xffff0000, v6
    v_mul_f32 v24, 0xc1200000, v24
    v_mul_f32 v25, 0xc1200000, v25
    v_cvt_pk_bf16_f32 v6, v24, v25
    v_lshlrev_b32 v24, 16, v6
    v_and_b32 v25, 0xffff0000, v6
    v_mul_f32 v24, 0x3fb8aa3b, v24
    v_mul_f32 v25, 0x3fb8aa3b, v25
    v_exp_f32 v24, v24
    v_exp_f32 v25, v25
    s_nop 0
    v_cvt_pk_bf16_f32 v6, v24, v25
    v_subrev_f32 v26, s26, v17
    v_subrev_f32 v27, s27, v17
    v_cvt_pk_bf16_f32 v10, v26, v27
    v_lshlrev_b32 v26, 16, v10
    v_and_b32 v27, 0xffff0000, v10
    v_mul_f32 v26, v26, v26
    v_mul_f32 v27, v27, v27
    v_cvt_pk_bf16_f32 v10, v26, v27
    v_lshlrev_b32 v26, 16, v10
    v_and_b32 v27, 0xffff0000, v10
    v_mul_f32 v26, 0xc1200000, v26
    v_mul_f32 v27, 0xc1200000, v27
    v_cvt_pk_bf16_f32 v10, v26, v27
    v_lshlrev_b32 v26, 16, v10
    v_and_b32 v27, 0xffff0000, v10
    v_mul_f32 v26, 0x3fb8aa3b, v26
    v_mul_f32 v27, 0x3fb8aa3b, v27
    v_exp_f32 v26, v26
    v_exp_f32 v27, v27
    s_nop 0
    v_cvt_pk_bf16_f32 v10, v26, v27
    v_subrev_f32 v24, s26, v18
    v_subrev_f32 v25, s27, v18
    v_cvt_pk_bf16_f32 v14, v24, v25
    v_lshlrev_b32 v24, 16, v14
    v_and_b32 v25, 0xffff0000, v14
    v_mul_f32 v24, v24, v24
    v_mul_f32 v25, v25, v25
    v_cvt_pk_bf16_f32 v14, v24, v25
    v_lshlrev_b32 v24, 16, v14
    v_and_b32 v25, 0xffff0000, v14
    v_mul_f32 v24, 0xc1200000, v24
    v_mul_f32 v25, 0xc1200000, v25
    v_cvt_pk_bf16_f32 v14, v24, v25
    v_lshlrev_b32 v24, 16, v14
    v_and_b32 v25, 0xffff0000, v14
    v_mul_f32 v24, 0x3fb8aa3b, v24
    v_mul_f32 v25, 0x3fb8aa3b, v25
    v_exp_f32 v24, v24
    v_exp_f32 v25, v25
    s_nop 0
    v_cvt_pk_bf16_f32 v14, v24, v25
    v_subrev_f32 v26, s26, v19
    v_subrev_f32 v27, s27, v19
    v_cvt_pk_bf16_f32 v122, v26, v27
    v_lshlrev_b32 v26, 16, v122
    v_and_b32 v27, 0xffff0000, v122
    v_mul_f32 v26, v26, v26
    v_mul_f32 v27, v27, v27
    v_cvt_pk_bf16_f32 v122, v26, v27
    v_lshlrev_b32 v26, 16, v122
    v_and_b32 v27, 0xffff0000, v122
    v_mul_f32 v26, 0xc1200000, v26
    v_mul_f32 v27, 0xc1200000, v27
    v_cvt_pk_bf16_f32 v122, v26, v27
    v_lshlrev_b32 v26, 16, v122
    v_and_b32 v27, 0xffff0000, v122
    v_mul_f32 v26, 0x3fb8aa3b, v26
    v_mul_f32 v27, 0x3fb8aa3b, v27
    v_exp_f32 v26, v26
    v_exp_f32 v27, v27
    s_nop 0
    v_cvt_pk_bf16_f32 v122, v26, v27
    s_lshl_b32 s26, s67, 16
    s_and_b32 s27, s67, 0xffff0000
    v_subrev_f32 v24, s26, v16
    v_subrev_f32 v25, s27, v16
    v_cvt_pk_bf16_f32 v7, v24, v25
    v_lshlrev_b32 v24, 16, v7
    v_and_b32 v25, 0xffff0000, v7
    v_mul_f32 v24, v24, v24
    v_mul_f32 v25, v25, v25
    v_cvt_pk_bf16_f32 v7, v24, v25
    v_lshlrev_b32 v24, 16, v7
    v_and_b32 v25, 0xffff0000, v7
    v_mul_f32 v24, 0xc1200000, v24
    v_mul_f32 v25, 0xc1200000, v25
    v_cvt_pk_bf16_f32 v7, v24, v25
    v_lshlrev_b32 v24, 16, v7
    v_and_b32 v25, 0xffff0000, v7
    v_mul_f32 v24, 0x3fb8aa3b, v24
    v_mul_f32 v25, 0x3fb8aa3b, v25
    v_exp_f32 v24, v24
    v_exp_f32 v25, v25
    s_nop 0
    v_cvt_pk_bf16_f32 v7, v24, v25
    v_subrev_f32 v26, s26, v17
    v_subrev_f32 v27, s27, v17
    v_cvt_pk_bf16_f32 v11, v26, v27
    v_lshlrev_b32 v26, 16, v11
    v_and_b32 v27, 0xffff0000, v11
    v_mul_f32 v26, v26, v26
    v_mul_f32 v27, v27, v27
    v_cvt_pk_bf16_f32 v11, v26, v27
    v_lshlrev_b32 v26, 16, v11
    v_and_b32 v27, 0xffff0000, v11
    v_mul_f32 v26, 0xc1200000, v26
    v_mul_f32 v27, 0xc1200000, v27
    v_cvt_pk_bf16_f32 v11, v26, v27
    v_lshlrev_b32 v26, 16, v11
    v_and_b32 v27, 0xffff0000, v11
    v_mul_f32 v26, 0x3fb8aa3b, v26
    v_mul_f32 v27, 0x3fb8aa3b, v27
    v_exp_f32 v26, v26
    v_exp_f32 v27, v27
    s_nop 0
    v_cvt_pk_bf16_f32 v11, v26, v27
    v_subrev_f32 v24, s26, v18
    v_subrev_f32 v25, s27, v18
    v_cvt_pk_bf16_f32 v15, v24, v25
    v_lshlrev_b32 v24, 16, v15
    v_and_b32 v25, 0xffff0000, v15
    v_mul_f32 v24, v24, v24
    v_mul_f32 v25, v25, v25
    v_cvt_pk_bf16_f32 v15, v24, v25
    v_lshlrev_b32 v24, 16, v15
    v_and_b32 v25, 0xffff0000, v15
    v_mul_f32 v24, 0xc1200000, v24
    v_mul_f32 v25, 0xc1200000, v25
    v_cvt_pk_bf16_f32 v15, v24, v25
    v_lshlrev_b32 v24, 16, v15
    v_and_b32 v25, 0xffff0000, v15
    v_mul_f32 v24, 0x3fb8aa3b, v24
    v_mul_f32 v25, 0x3fb8aa3b, v25
    v_exp_f32 v24, v24
    v_exp_f32 v25, v25
    s_nop 0
    v_cvt_pk_bf16_f32 v15, v24, v25
    v_subrev_f32 v26, s26, v19
    v_subrev_f32 v27, s27, v19
    v_cvt_pk_bf16_f32 v123, v26, v27
    v_lshlrev_b32 v26, 16, v123
    v_and_b32 v27, 0xffff0000, v123
    v_mul_f32 v26, v26, v26
    v_mul_f32 v27, v27, v27
    v_cvt_pk_bf16_f32 v123, v26, v27
    v_lshlrev_b32 v26, 16, v123
    v_and_b32 v27, 0xffff0000, v123
    v_mul_f32 v26, 0xc1200000, v26
    v_mul_f32 v27, 0xc1200000, v27
    v_cvt_pk_bf16_f32 v123, v26, v27
    v_lshlrev_b32 v26, 16, v123
    v_and_b32 v27, 0xffff0000, v123
    v_mul_f32 v26, 0x3fb8aa3b, v26
    v_mul_f32 v27, 0x3fb8aa3b, v27
    v_exp_f32 v26, v26
    v_exp_f32 v27, v27
    s_nop 0
    v_cvt_pk_bf16_f32 v123, v26, v27
    s_waitcnt lgkmcnt(0)
    s_load_dwordx16 s[84:99], s[8:9], 0
    s_load_dwordx16 s[36:51], s[10:11], 0
    s_load_dwordx16 s[52:67], s[10:11], 64
    s_load_dwordx16 s[68:83], s[10:11], 128
    s_mov_b64 s[100:101], s[14:15]
    s_load_dwordx8 s[8:15], s[12:13], 0
    s_waitcnt lgkmcnt(0)
    s_pack_ll_b32_b16 s26, s84, s86
    s_pack_hh_b32_b16 s27, s84, s86
    v_dot2_f32_bf16 v16, v4, s26, 0
    v_dot2_f32_bf16 v17, v4, s27, 0
    v_dot2_f32_bf16 v24, v8, s26, 0
    v_dot2_f32_bf16 v25, v8, s27, 0
    v_dot2_f32_bf16 v124, v12, s26, 0
    v_dot2_f32_bf16 v125, v12, s27, 0
    s_pack_ll_b32_b16 s26, s85, s87
    s_pack_hh_b32_b16 s27, s85, s87
    v_dot2_f32_bf16 v18, v4, s26, 0
    v_dot2_f32_bf16 v19, v4, s27, 0
    v_dot2_f32_bf16 v26, v8, s26, 0
    v_dot2_f32_bf16 v27, v8, s27, 0
    v_dot2_f32_bf16 v126, v12, s26, 0
    v_dot2_f32_bf16 v127, v12, s27, 0
    s_pack_ll_b32_b16 s26, s88, s90
    s_pack_hh_b32_b16 s27, s88, s90
    v_dot2_f32_bf16 v16, v5, s26, v16
    v_dot2_f32_bf16 v17, v5, s27, v17
    v_dot2_f32_bf16 v24, v9, s26, v24
    v_dot2_f32_bf16 v25, v9, s27, v25
    v_dot2_f32_bf16 v124, v13, s26, v124
    v_dot2_f32_bf16 v125, v13, s27, v125
    s_pack_ll_b32_b16 s26, s89, s91
    s_pack_hh_b32_b16 s27, s89, s91
    v_dot2_f32_bf16 v18, v5, s26, v18
    v_dot2_f32_bf16 v19, v5, s27, v19
    v_dot2_f32_bf16 v26, v9, s26, v26
    v_dot2_f32_bf16 v27, v9, s27, v27
    v_dot2_f32_bf16 v126, v13, s26, v126
    v_dot2_f32_bf16 v127, v13, s27, v127
    s_pack_ll_b32_b16 s26, s92, s94
    s_pack_hh_b32_b16 s27, s92, s94
    v_dot2_f32_bf16 v16, v6, s26, v16
    v_dot2_f32_bf16 v17, v6, s27, v17
    v_dot2_f32_bf16 v24, v10, s26, v24
    v_dot2_f32_bf16 v25, v10, s27, v25
    v_dot2_f32_bf16 v124, v14, s26, v124
    v_dot2_f32_bf16 v125, v14, s27, v125
    s_pack_ll_b32_b16 s26, s93, s95
    s_pack_hh_b32_b16 s27, s93, s95
    v_dot2_f32_bf16 v18, v6, s26, v18
    v_dot2_f32_bf16 v19, v6, s27, v19
    v_dot2_f32_bf16 v26, v10, s26, v26
    v_dot2_f32_bf16 v27, v10, s27, v27
    v_dot2_f32_bf16 v126, v14, s26, v126
    v_dot2_f32_bf16 v127, v14, s27, v127
    s_pack_ll_b32_b16 s26, s96, s98
    s_pack_hh_b32_b16 s27, s96, s98
    v_dot2_f32_bf16 v16, v7, s26, v16
    v_dot2_f32_bf16 v17, v7, s27, v17
    v_dot2_f32_bf16 v24, v11, s26, v24
    v_dot2_f32_bf16 v25, v11, s27, v25
    v_dot2_f32_bf16 v124, v15, s26, v124
    v_dot2_f32_bf16 v125, v15, s27, v125
    s_pack_ll_b32_b16 s26, s97, s99
    s_pack_hh_b32_b16 s27, s97, s99
    v_dot2_f32_bf16 v18, v7, s26, v18
    v_dot2_f32_bf16 v19, v7, s27, v19
    v_dot2_f32_bf16 v26, v11, s26, v26
    v_dot2_f32_bf16 v27, v11, s27, v27
    v_dot2_f32_bf16 v126, v15, s26, v126
    v_dot2_f32_bf16 v127, v15, s27, v127
    s_pack_ll_b32_b16 s26, s36, s42
    s_pack_hh_b32_b16 s27, s36, s42
    v_dot2_f32_bf16 v28, v4, s26, 0
    v_dot2_f32_bf16 v29, v4, s27, 0
    v_dot2_f32_bf16 v92, v8, s26, 0
    v_dot2_f32_bf16 v93, v8, s27, 0
    v_dot2_f32_bf16 v106, v12, s26, 0
    v_dot2_f32_bf16 v107, v12, s27, 0
    s_pack_ll_b32_b16 s26, s37, s43
    s_pack_hh_b32_b16 s27, s37, s43
    v_dot2_f32_bf16 v30, v4, s26, 0
    v_dot2_f32_bf16 v31, v4, s27, 0
    v_dot2_f32_bf16 v94, v8, s26, 0
    v_dot2_f32_bf16 v95, v8, s27, 0
    v_dot2_f32_bf16 v108, v12, s26, 0
    v_dot2_f32_bf16 v109, v12, s27, 0
    s_pack_ll_b32_b16 s26, s48, s54
    s_pack_hh_b32_b16 s27, s48, s54
    v_dot2_f32_bf16 v28, v5, s26, v28
    v_dot2_f32_bf16 v29, v5, s27, v29
    v_dot2_f32_bf16 v92, v9, s26, v92
    v_dot2_f32_bf16 v93, v9, s27, v93
    v_dot2_f32_bf16 v106, v13, s26, v106
    v_dot2_f32_bf16 v107, v13, s27, v107
    s_pack_ll_b32_b16 s26, s49, s55
    s_pack_hh_b32_b16 s27, s49, s55
    v_dot2_f32_bf16 v30, v5, s26, v30
    v_dot2_f32_bf16 v31, v5, s27, v31
    v_dot2_f32_bf16 v94, v9, s26, v94
    v_dot2_f32_bf16 v95, v9, s27, v95
    v_dot2_f32_bf16 v108, v13, s26, v108
    v_dot2_f32_bf16 v109, v13, s27, v109
    s_pack_ll_b32_b16 s26, s60, s66
    s_pack_hh_b32_b16 s27, s60, s66
    v_dot2_f32_bf16 v28, v6, s26, v28
    v_dot2_f32_bf16 v29, v6, s27, v29
    v_dot2_f32_bf16 v92, v10, s26, v92
    v_dot2_f32_bf16 v93, v10, s27, v93
    v_dot2_f32_bf16 v106, v14, s26, v106
    v_dot2_f32_bf16 v107, v14, s27, v107
    s_pack_ll_b32_b16 s26, s61, s67
    s_pack_hh_b32_b16 s27, s61, s67
    v_dot2_f32_bf16 v30, v6, s26, v30
    v_dot2_f32_bf16 v31, v6, s27, v31
    v_dot2_f32_bf16 v94, v10, s26, v94
    v_dot2_f32_bf16 v95, v10, s27, v95
    v_dot2_f32_bf16 v108, v14, s26, v108
    v_dot2_f32_bf16 v109, v14, s27, v109
    s_pack_ll_b32_b16 s26, s72, s78
    s_pack_hh_b32_b16 s27, s72, s78
    v_dot2_f32_bf16 v28, v7, s26, v28
    v_dot2_f32_bf16 v29, v7, s27, v29
    v_dot2_f32_bf16 v92, v11, s26, v92
    v_dot2_f32_bf16 v93, v11, s27, v93
    v_dot2_f32_bf16 v106, v15, s26, v106
    v_dot2_f32_bf16 v107, v15, s27, v107
    s_pack_ll_b32_b16 s26, s73, s79
    s_pack_hh_b32_b16 s27, s73, s79
    v_dot2_f32_bf16 v30, v7, s26, v30
    v_dot2_f32_bf16 v31, v7, s27, v31
    v_dot2_f32_bf16 v94, v11, s26, v94
    v_dot2_f32_bf16 v95, v11, s27, v95
    v_dot2_f32_bf16 v108, v15, s26, v108
    v_dot2_f32_bf16 v109, v15, s27, v109
    s_pack_ll_b32_b16 s26, s38, s44
    s_pack_hh_b32_b16 s27, s38, s44
    v_dot2_f32_bf16 v32, v4, s26, 0
    v_dot2_f32_bf16 v33, v4, s27, 0
    v_dot2_f32_bf16 v96, v8, s26, 0
    v_dot2_f32_bf16 v97, v8, s27, 0
    v_dot2_f32_bf16 v110, v12, s26, 0
    v_dot2_f32_bf16 v111, v12, s27, 0
    s_pack_ll_b32_b16 s26, s39, s45
    s_pack_hh_b32_b16 s27, s39, s45
    v_dot2_f32_bf16 v34, v4, s26, 0
    v_dot2_f32_bf16 v35, v4, s27, 0
    v_dot2_f32_bf16 v98, v8, s26, 0
    v_dot2_f32_bf16 v99, v8, s27, 0
    v_dot2_f32_bf16 v112, v12, s26, 0
    v_dot2_f32_bf16 v113, v12, s27, 0
    s_pack_ll_b32_b16 s26, s50, s56
    s_pack_hh_b32_b16 s27, s50, s56
    v_dot2_f32_bf16 v32, v5, s26, v32
    v_dot2_f32_bf16 v33, v5, s27, v33
    v_dot2_f32_bf16 v96, v9, s26, v96
    v_dot2_f32_bf16 v97, v9, s27, v97
    v_dot2_f32_bf16 v110, v13, s26, v110
    v_dot2_f32_bf16 v111, v13, s27, v111
    s_pack_ll_b32_b16 s26, s51, s57
    s_pack_hh_b32_b16 s27, s51, s57
    v_dot2_f32_bf16 v34, v5, s26, v34
    v_dot2_f32_bf16 v35, v5, s27, v35
    v_dot2_f32_bf16 v98, v9, s26, v98
    v_dot2_f32_bf16 v99, v9, s27, v99
    v_dot2_f32_bf16 v112, v13, s26, v112
    v_dot2_f32_bf16 v113, v13, s27, v113
    s_pack_ll_b32_b16 s26, s62, s68
    s_pack_hh_b32_b16 s27, s62, s68
    v_dot2_f32_bf16 v32, v6, s26, v32
    v_dot2_f32_bf16 v33, v6, s27, v33
    v_dot2_f32_bf16 v96, v10, s26, v96
    v_dot2_f32_bf16 v97, v10, s27, v97
    v_dot2_f32_bf16 v110, v14, s26, v110
    v_dot2_f32_bf16 v111, v14, s27, v111
    s_pack_ll_b32_b16 s26, s63, s69
    s_pack_hh_b32_b16 s27, s63, s69
    v_dot2_f32_bf16 v34, v6, s26, v34
    v_dot2_f32_bf16 v35, v6, s27, v35
    v_dot2_f32_bf16 v98, v10, s26, v98
    v_dot2_f32_bf16 v99, v10, s27, v99
    v_dot2_f32_bf16 v112, v14, s26, v112
    v_dot2_f32_bf16 v113, v14, s27, v113
    s_pack_ll_b32_b16 s26, s74, s80
    s_pack_hh_b32_b16 s27, s74, s80
    v_dot2_f32_bf16 v32, v7, s26, v32
    v_dot2_f32_bf16 v33, v7, s27, v33
    v_dot2_f32_bf16 v96, v11, s26, v96
    v_dot2_f32_bf16 v97, v11, s27, v97
    v_dot2_f32_bf16 v110, v15, s26, v110
    v_dot2_f32_bf16 v111, v15, s27, v111
    s_pack_ll_b32_b16 s26, s75, s81
    s_pack_hh_b32_b16 s27, s75, s81
    v_dot2_f32_bf16 v34, v7, s26, v34
    v_dot2_f32_bf16 v35, v7, s27, v35
    v_dot2_f32_bf16 v98, v11, s26, v98
    v_dot2_f32_bf16 v99, v11, s27, v99
    v_dot2_f32_bf16 v112, v15, s26, v112
    v_dot2_f32_bf16 v113, v15, s27, v113
    s_pack_ll_b32_b16 s26, s40, s46
    s_pack_hh_b32_b16 s27, s40, s46
    v_dot2_f32_bf16 v36, v4, s26, 0
    v_dot2_f32_bf16 v37, v4, s27, 0
    v_dot2_f32_bf16 v100, v8, s26, 0
    v_dot2_f32_bf16 v101, v8, s27, 0
    v_dot2_f32_bf16 v114, v12, s26, 0
    v_dot2_f32_bf16 v115, v12, s27, 0
    s_pack_ll_b32_b16 s26, s41, s47
    s_pack_hh_b32_b16 s27, s41, s47
    v_dot2_f32_bf16 v38, v4, s26, 0
    v_dot2_f32_bf16 v39, v4, s27, 0
    v_dot2_f32_bf16 v102, v8, s26, 0
    v_dot2_f32_bf16 v103, v8, s27, 0
    v_dot2_f32_bf16 v116, v12, s26, 0
    v_dot2_f32_bf16 v117, v12, s27, 0
    s_pack_ll_b32_b16 s26, s52, s58
    s_pack_hh_b32_b16 s27, s52, s58
    v_dot2_f32_bf16 v36, v5, s26, v36
    v_dot2_f32_bf16 v37, v5, s27, v37
    v_dot2_f32_bf16 v100, v9, s26, v100
    v_dot2_f32_bf16 v101, v9, s27, v101
    v_dot2_f32_bf16 v114, v13, s26, v114
    v_dot2_f32_bf16 v115, v13, s27, v115
    s_pack_ll_b32_b16 s26, s53, s59
    s_pack_hh_b32_b16 s27, s53, s59
    v_dot2_f32_bf16 v38, v5, s26, v38
    v_dot2_f32_bf16 v39, v5, s27, v39
    v_dot2_f32_bf16 v102, v9, s26, v102
    v_dot2_f32_bf16 v103, v9, s27, v103
    v_dot2_f32_bf16 v116, v13, s26, v116
    v_dot2_f32_bf16 v117, v13, s27, v117
    s_pack_ll_b32_b16 s26, s64, s70
    s_pack_hh_b32_b16 s27, s64, s70
    v_dot2_f32_bf16 v36, v6, s26, v36
    v_dot2_f32_bf16 v37, v6, s27, v37
    v_dot2_f32_bf16 v100, v10, s26, v100
    v_dot2_f32_bf16 v101, v10, s27, v101
    v_dot2_f32_bf16 v114, v14, s26, v114
    v_dot2_f32_bf16 v115, v14, s27, v115
    s_pack_ll_b32_b16 s26, s65, s71
    s_pack_hh_b32_b16 s27, s65, s71
    v_dot2_f32_bf16 v38, v6, s26, v38
    v_dot2_f32_bf16 v39, v6, s27, v39
    v_dot2_f32_bf16 v102, v10, s26, v102
    v_dot2_f32_bf16 v103, v10, s27, v103
    v_dot2_f32_bf16 v116, v14, s26, v116
    v_dot2_f32_bf16 v117, v14, s27, v117
    s_pack_ll_b32_b16 s26, s76, s82
    s_pack_hh_b32_b16 s27, s76, s82
    v_dot2_f32_bf16 v36, v7, s26, v36
    v_dot2_f32_bf16 v37, v7, s27, v37
    v_dot2_f32_bf16 v100, v11, s26, v100
    v_dot2_f32_bf16 v101, v11, s27, v101
    v_dot2_f32_bf16 v114, v15, s26, v114
    v_dot2_f32_bf16 v115, v15, s27, v115
    s_pack_ll_b32_b16 s26, s77, s83
    s_pack_hh_b32_b16 s27, s77, s83
    v_dot2_f32_bf16 v38, v7, s26, v38
    v_dot2_f32_bf16 v39, v7, s27, v39
    v_dot2_f32_bf16 v102, v11, s26, v102
    v_dot2_f32_bf16 v103, v11, s27, v103
    v_dot2_f32_bf16 v116, v15, s26, v116
    v_dot2_f32_bf16 v117, v15, s27, v117
    v_cvt_pk_bf16_f32 v40, v16, v17
    v_cvt_pk_bf16_f32 v41, v18, v19
    v_cvt_pk_bf16_f32 v104, v24, v25
    v_cvt_pk_bf16_f32 v105, v26, v27
    v_cvt_pk_bf16_f32 v118, v124, v125
    v_cvt_pk_bf16_f32 v119, v126, v127
    s_nop 2
    s_setprio 3
    s_mov_b32 s22, 6
b_cloop:
    s_barrier
    s_cmp_eq_u32 s3, 8
    s_cbranch_scc1 b_w40
    ds_read_b32 v4, v3 offset:0
    ds_read_b32 v8, v3 offset:2048
    ds_read_b32 v12, v3 offset:4096
    v_mov_b32 v2, 800
    s_waitcnt lgkmcnt(2)
    v_lshlrev_b32 v1, 4, v4
    ds_write_b32 v3, v2 offset:0
    ds_read_b128 v[4:7], v1
    s_waitcnt lgkmcnt(3)
    v_lshlrev_b32 v1, 4, v8
    ds_write_b32 v3, v2 offset:2048
    ds_read_b128 v[8:11], v1
    s_waitcnt lgkmcnt(4)
    v_lshlrev_b32 v1, 4, v12
    ds_write_b32 v3, v2 offset:4096
    ds_read_b128 v[12:15], v1
    v_mov_b32 v2, 12800
b_wa0:
    s_waitcnt lgkmcnt(2)
    v_lshlrev_b32_sdwa v1, 4, v7 dst_sel:DWORD dst_unused:UNUSED_PAD src0_sel:DWORD src1_sel:WORD_0
    v_lshlrev_b32 v20, 16, v4
    v_lshlrev_b32 v21, 16, v5
    v_lshlrev_b32 v42, 16, v6
    v_and_b32 v24, s34, v4
    v_and_b32 v25, s34, v5
    v_and_b32 v26, s34, v6
    v_and_b32 v27, s34, v7
    ds_read_b128 v[4:7], v1
    v_cmp_ne_u32 vcc, v1, v2
    v_pk_fma_f32 v[44:45], v[20:21], v[42:43], v[44:45] op_sel:[0,0,0] op_sel_hi:[1,0,1]
    v_pk_fma_f32 v[46:47], v[24:25], v[42:43], v[46:47] op_sel:[0,0,0] op_sel_hi:[1,0,1]
    v_pk_fma_f32 v[48:49], v[20:21], v[26:27], v[48:49] op_sel:[0,0,0] op_sel_hi:[1,0,1]
    v_pk_fma_f32 v[50:51], v[24:25], v[26:27], v[50:51] op_sel:[0,0,0] op_sel_hi:[1,0,1]
    v_pk_fma_f32 v[52:53], v[20:21], v[26:27], v[52:53] op_sel:[0,1,0] op_sel_hi:[1,1,1]
    v_pk_fma_f32 v[54:55], v[24:25], v[26:27], v[54:55] op_sel:[0,1,0] op_sel_hi:[1,1,1]
    s_waitcnt lgkmcnt(2)
    v_lshlrev_b32_sdwa v1, 4, v11 dst_sel:DWORD dst_unused:UNUSED_PAD src0_sel:DWORD src1_sel:WORD_0
    v_lshlrev_b32 v20, 16, v8
    v_lshlrev_b32 v21, 16, v9
    v_lshlrev_b32 v42, 16, v10
    v_and_b32 v24, s34, v8
    v_and_b32 v25, s34, v9
    v_and_b32 v26, s34, v10
    v_and_b32 v27, s34, v11
    ds_read_b128 v[8:11], v1
    v_cmp_ne_u32 s[28:29], v1, v2
    v_pk_fma_f32 v[56:57], v[20:21], v[42:43], v[56:57] op_sel:[0,0,0] op_sel_hi:[1,0,1]
    v_pk_fma_f32 v[58:59], v[24:25], v[42:43], v[58:59] op_sel:[0,0,0] op_sel_hi:[1,0,1]
    v_pk_fma_f32 v[60:61], v[20:21], v[26:27], v[60:61] op_sel:[0,0,0] op_sel_hi:[1,0,1]
    v_pk_fma_f32 v[62:63], v[24:25], v[26:27], v[62:63] op_sel:[0,0,0] op_sel_hi:[1,0,1]
    v_pk_fma_f32 v[64:65], v[20:21], v[26:27], v[64:65] op_sel:[0,1,0] op_sel_hi:[1,1,1]
    v_pk_fma_f32 v[66:67], v[24:25], v[26:27], v[66:67] op_sel:[0,1,0] op_sel_hi:[1,1,1]
    s_or_b64 vcc, vcc, s[28:29]
    s_waitcnt lgkmcnt(2)
    v_lshlrev_b32_sdwa v1, 4, v15 dst_sel:DWORD dst_unused:UNUSED_PAD src0_sel:DWORD src1_sel:WORD_0
    v_lshlrev_b32 v20, 16, v12
    v_lshlrev_b32 v21, 16, v13
    v_lshlrev_b32 v42, 16, v14
    v_and_b32 v24, s34, v12
    v_and_b32 v25, s34, v13
    v_and_b32 v26, s34, v14
    v_and_b32 v27, s34, v15
    ds_read_b128 v[12:15], v1
    v_cmp_ne_u32 s[28:29], v1, v2
    v_pk_fma_f32 v[68:69], v[20:21], v[42:43], v[68:69] op_sel:[0,0,0] op_sel_hi:[1,0,1]
    v_pk_fma_f32 v[70:71], v[24:25], v[42:43], v[70:71] op_sel:[0,0,0] op_sel_hi:[1,0,1]
    v_pk_fma_f32 v[72:73], v[20:21], v[26:27], v[72:73] op_sel:[0,0,0] op_sel_hi:[1,0,1]
    v_pk_fma_f32 v[74:75], v[24:25], v[26:27], v[74:75] op_sel:[0,0,0] op_sel_hi:[1,0,1]
    v_pk_fma_f32 v[76:77], v[20:21], v[26:27], v[76:77] op_sel:[0,1,0] op_sel_hi:[1,1,1]
    v_pk_fma_f32 v[78:79], v[24:25], v[26:27], v[78:79] op_sel:[0,1,0] op_sel_hi:[1,1,1]
    s_or_b64 vcc, vcc, s[28:29]
    s_cbranch_vccnz b_wa0
    s_waitcnt lgkmcnt(0)
    s_branch b_wdone0
b_w40:
    ds_read_b32 v4, v3 offset:0
    ds_read_b32 v8, v3 offset:2048
    ds_read_b32 v12, v3 offset:4096
    ds_read_b32 v16, v3 offset:6144
    v_mov_b32 v2, 800
    s_waitcnt lgkmcnt(3)
    v_lshlrev_b32 v1, 4, v4
    ds_write_b32 v3, v2 offset:0
    ds_read_b128 v[4:7], v1
    s_waitcnt lgkmcnt(4)
    v_lshlrev_b32 v1, 4, v8
    ds_write_b32 v3, v2 offset:2048
    ds_read_b128 v[8:11], v1
    s_waitcnt lgkmcnt(5)
    v_lshlrev_b32 v1, 4, v12
    ds_write_b32 v3, v2 offset:4096
    ds_read_b128 v[12:15], v1
    s_waitcnt lgkmcnt(6)
    v_lshlrev_b32 v1, 4, v16
    ds_write_b32 v3, v2 offset:6144
    ds_read_b128 v[16:19], v1
    v_mov_b32 v2, 12800
b_wb0:
    s_waitcnt lgkmcnt(3)
    v_lshlrev_b32_sdwa v1, 4, v7 dst_sel:DWORD dst_unused:UNUSED_PAD src0_sel:DWORD src1_sel:WORD_0
    v_lshlrev_b32 v20, 16, v4
    v_lshlrev_b32 v21, 16, v5
    v_lshlrev_b32 v42, 16, v6
    v_and_b32 v24, s34, v4
    v_and_b32 v25, s34, v5
    v_and_b32 v26, s34, v6
    v_and_b32 v27, s34, v7
    ds_read_b128 v[4:7], v1
    v_cmp_ne_u32 vcc, v1, v2
    v_pk_fma_f32 v[44:45], v[20:21], v[42:43], v[44:45] op_sel:[0,0,0] op_sel_hi:[1,0,1]
    v_pk_fma_f32 v[46:47], v[24:25], v[42:43], v[46:47] op_sel:[0,0,0] op_sel_hi:[1,0,1]
    v_pk_fma_f32 v[48:49], v[20:21], v[26:27], v[48:49] op_sel:[0,0,0] op_sel_hi:[1,0,1]
    v_pk_fma_f32 v[50:51], v[24:25], v[26:27], v[50:51] op_sel:[0,0,0] op_sel_hi:[1,0,1]
    v_pk_fma_f32 v[52:53], v[20:21], v[26:27], v[52:53] op_sel:[0,1,0] op_sel_hi:[1,1,1]
    v_pk_fma_f32 v[54:55], v[24:25], v[26:27], v[54:55] op_sel:[0,1,0] op_sel_hi:[1,1,1]
    s_waitcnt lgkmcnt(3)
    v_lshlrev_b32_sdwa v1, 4, v11 dst_sel:DWORD dst_unused:UNUSED_PAD src0_sel:DWORD src1_sel:WORD_0
    v_lshlrev_b32 v20, 16, v8
    v_lshlrev_b32 v21, 16, v9
    v_lshlrev_b32 v42, 16, v10
    v_and_b32 v24, s34, v8
    v_and_b32 v25, s34, v9
    v_and_b32 v26, s34, v10
    v_and_b32 v27, s34, v11
    ds_read_b128 v[8:11], v1
    v_cmp_ne_u32 s[28:29], v1, v2
    v_pk_fma_f32 v[56:57], v[20:21], v[42:43], v[56:57] op_sel:[0,0,0] op_sel_hi:[1,0,1]
    v_pk_fma_f32 v[58:59], v[24:25], v[42:43], v[58:59] op_sel:[0,0,0] op_sel_hi:[1,0,1]
    v_pk_fma_f32 v[60:61], v[20:21], v[26:27], v[60:61] op_sel:[0,0,0] op_sel_hi:[1,0,1]
    v_pk_fma_f32 v[62:63], v[24:25], v[26:27], v[62:63] op_sel:[0,0,0] op_sel_hi:[1,0,1]
    v_pk_fma_f32 v[64:65], v[20:21], v[26:27], v[64:65] op_sel:[0,1,0] op_sel_hi:[1,1,1]
    v_pk_fma_f32 v[66:67], v[24:25], v[26:27], v[66:67] op_sel:[0,1,0] op_sel_hi:[1,1,1]
    s_or_b64 vcc, vcc, s[28:29]
    s_waitcnt lgkmcnt(3)
    v_lshlrev_b32_sdwa v1, 4, v15 dst_sel:DWORD dst_unused:UNUSED_PAD src0_sel:DWORD src1_sel:WORD_0
    v_lshlrev_b32 v20, 16, v12
    v_lshlrev_b32 v21, 16, v13
    v_lshlrev_b32 v42, 16, v14
    v_and_b32 v24, s34, v12
    v_and_b32 v25, s34, v13
    v_and_b32 v26, s34, v14
    v_and_b32 v27, s34, v15
    ds_read_b128 v[12:15], v1
    v_cmp_ne_u32 s[28:29], v1, v2
    v_pk_fma_f32 v[68:69], v[20:21], v[42:43], v[68:69] op_sel:[0,0,0] op_sel_hi:[1,0,1]
    v_pk_fma_f32 v[70:71], v[24:25], v[42:43], v[70:71] op_sel:[0,0,0] op_sel_hi:[1,0,1]
    v_pk_fma_f32 v[72:73], v[20:21], v[26:27], v[72:73] op_sel:[0,0,0] op_sel_hi:[1,0,1]
    v_pk_fma_f32 v[74:75], v[24:25], v[26:27], v[74:75] op_sel:[0,0,0] op_sel_hi:[1,0,1]
    v_pk_fma_f32 v[76:77], v[20:21], v[26:27], v[76:77] op_sel:[0,1,0] op_sel_hi:[1,1,1]
    v_pk_fma_f32 v[78:79], v[24:25], v[26:27], v[78:79] op_sel:[0,1,0] op_sel_hi:[1,1,1]
    s_or_b64 vcc, vcc, s[28:29]
    s_waitcnt lgkmcnt(3)
    v_lshlrev_b32_sdwa v1, 4, v19 dst_sel:DWORD dst_unused:UNUSED_PAD src0_sel:DWORD src1_sel:WORD_0
    v_lshlrev_b32 v20, 16, v16
    v_lshlrev_b32 v21, 16, v17
    v_lshlrev_b32 v42, 16, v18
    v_and_b32 v24, s34, v16
    v_and_b32 v25, s34, v17
    v_and_b32 v26, s34, v18
    v_and_b32 v27, s34, v19
    ds_read_b128 v[16:19], v1
    v_cmp_ne_u32 s[28:29], v1, v2
    v_pk_fma_f32 v[80:81], v[20:21], v[42:43], v[80:81] op_sel:[0,0,0] op_sel_hi:[1,0,1]
    v_pk_fma_f32 v[82:83], v[24:25], v[42:43], v[82:83] op_sel:[0,0,0] op_sel_hi:[1,0,1]
    v_pk_fma_f32 v[84:85], v[20:21], v[26:27], v[84:85] op_sel:[0,0,0] op_sel_hi:[1,0,1]
    v_pk_fma_f32 v[86:87], v[24:25], v[26:27], v[86:87] op_sel:[0,0,0] op_sel_hi:[1,0,1]
    v_pk_fma_f32 v[88:89], v[20:21], v[26:27], v[88:89] op_sel:[0,1,0] op_sel_hi:[1,1,1]
    v_pk_fma_f32 v[90:91], v[24:25], v[26:27], v[90:91] op_sel:[0,1,0] op_sel_hi:[1,1,1]
    s_or_b64 vcc, vcc, s[28:29]
    s_cbranch_vccnz b_wb0
    s_waitcnt lgkmcnt(0)
b_wdone0:
    s_sub_u32 s22, s22, 1
    s_cmp_eq_u32 s22, 0
    s_cbranch_scc1 b_cend
    s_barrier
    s_cmp_eq_u32 s3, 8
    s_cbranch_scc1 b_w41
    ds_read_b32 v4, v3 offset:6400
    ds_read_b32 v8, v3 offset:8448
    ds_read_b32 v12, v3 offset:10496
    v_mov_b32 v2, 800
    s_waitcnt lgkmcnt(2)
    v_lshlrev_b32 v1, 4, v4
    ds_write_b32 v3, v2 offset:6400
    ds_read_b128 v[4:7], v1
    s_waitcnt lgkmcnt(3)
    v_lshlrev_b32 v1, 4, v8
    ds_write_b32 v3, v2 offset:8448
    ds_read_b128 v[8:11], v1
    s_waitcnt lgkmcnt(4)
    v_lshlrev_b32 v1, 4, v12
    ds_write_b32 v3, v2 offset:10496
    ds_read_b128 v[12:15], v1
    v_mov_b32 v2, 12800
b_wa1:
    s_waitcnt lgkmcnt(2)
    v_lshlrev_b32_sdwa v1, 4, v7 dst_sel:DWORD dst_unused:UNUSED_PAD src0_sel:DWORD src1_sel:WORD_0
    v_lshlrev_b32 v20, 16, v4
    v_lshlrev_b32 v21, 16, v5
    v_lshlrev_b32 v42, 16, v6
    v_and_b32 v24, s34, v4
    v_and_b32 v25, s34, v5
    v_and_b32 v26, s34, v6
    v_and_b32 v27, s34, v7
    ds_read_b128 v[4:7], v1
    v_cmp_ne_u32 vcc, v1, v2
    v_pk_fma_f32 v[44:45], v[20:21], v[42:43], v[44:45] op_sel:[0,0,0] op_sel_hi:[1,0,1]
    v_pk_fma_f32 v[46:47], v[24:25], v[42:43], v[46:47] op_sel:[0,0,0] op_sel_hi:[1,0,1]
    v_pk_fma_f32 v[48:49], v[20:21], v[26:27], v[48:49] op_sel:[0,0,0] op_sel_hi:[1,0,1]
    v_pk_fma_f32 v[50:51], v[24:25], v[26:27], v[50:51] op_sel:[0,0,0] op_sel_hi:[1,0,1]
    v_pk_fma_f32 v[52:53], v[20:21], v[26:27], v[52:53] op_sel:[0,1,0] op_sel_hi:[1,1,1]
    v_pk_fma_f32 v[54:55], v[24:25], v[26:27], v[54:55] op_sel:[0,1,0] op_sel_hi:[1,1,1]
    s_waitcnt lgkmcnt(2)
    v_lshlrev_b32_sdwa v1, 4, v11 dst_sel:DWORD dst_unused:UNUSED_PAD src0_sel:DWORD src1_sel:WORD_0
    v_lshlrev_b32 v20, 16, v8
    v_lshlrev_b32 v21, 16, v9
    v_lshlrev_b32 v42, 16, v10
    v_and_b32 v24, s34, v8
    v_and_b32 v25, s34, v9
    v_and_b32 v26, s34, v10
    v_and_b32 v27, s34, v11
    ds_read_b128 v[8:11], v1
    v_cmp_ne_u32 s[28:29], v1, v2
    v_pk_fma_f32 v[56:57], v[20:21], v[42:43], v[56:57] op_sel:[0,0,0] op_sel_hi:[1,0,1]
    v_pk_fma_f32 v[58:59], v[24:25], v[42:43], v[58:59] op_sel:[0,0,0] op_sel_hi:[1,0,1]
    v_pk_fma_f32 v[60:61], v[20:21], v[26:27], v[60:61] op_sel:[0,0,0] op_sel_hi:[1,0,1]
    v_pk_fma_f32 v[62:63], v[24:25], v[26:27], v[62:63] op_sel:[0,0,0] op_sel_hi:[1,0,1]
    v_pk_fma_f32 v[64:65], v[20:21], v[26:27], v[64:65] op_sel:[0,1,0] op_sel_hi:[1,1,1]
    v_pk_fma_f32 v[66:67], v[24:25], v[26:27], v[66:67] op_sel:[0,1,0] op_sel_hi:[1,1,1]
    s_or_b64 vcc, vcc, s[28:29]
    s_waitcnt lgkmcnt(2)
    v_lshlrev_b32_sdwa v1, 4, v15 dst_sel:DWORD dst_unused:UNUSED_PAD src0_sel:DWORD src1_sel:WORD_0
    v_lshlrev_b32 v20, 16, v12
    v_lshlrev_b32 v21, 16, v13
    v_lshlrev_b32 v42, 16, v14
    v_and_b32 v24, s34, v12
    v_and_b32 v25, s34, v13
    v_and_b32 v26, s34, v14
    v_and_b32 v27, s34, v15
    ds_read_b128 v[12:15], v1
    v_cmp_ne_u32 s[28:29], v1, v2
    v_pk_fma_f32 v[68:69], v[20:21], v[42:43], v[68:69] op_sel:[0,0,0] op_sel_hi:[1,0,1]
    v_pk_fma_f32 v[70:71], v[24:25], v[42:43], v[70:71] op_sel:[0,0,0] op_sel_hi:[1,0,1]
    v_pk_fma_f32 v[72:73], v[20:21], v[26:27], v[72:73] op_sel:[0,0,0] op_sel_hi:[1,0,1]
    v_pk_fma_f32 v[74:75], v[24:25], v[26:27], v[74:75] op_sel:[0,0,0] op_sel_hi:[1,0,1]
    v_pk_fma_f32 v[76:77], v[20:21], v[26:27], v[76:77] op_sel:[0,1,0] op_sel_hi:[1,1,1]
    v_pk_fma_f32 v[78:79], v[24:25], v[26:27], v[78:79] op_sel:[0,1,0] op_sel_hi:[1,1,1]
    s_or_b64 vcc, vcc, s[28:29]
    s_cbranch_vccnz b_wa1
    s_waitcnt lgkmcnt(0)
    s_branch b_wdone1
b_w41:
    ds_read_b32 v4, v3 offset:6400
    ds_read_b32 v8, v3 offset:8448
    ds_read_b32 v12, v3 offset:10496
    ds_read_b32 v16, v3 offset:12544
    v_mov_b32 v2, 800
    s_waitcnt lgkmcnt(3)
    v_lshlrev_b32 v1, 4, v4
    ds_write_b32 v3, v2 offset:6400
    ds_read_b128 v[4:7], v1
    s_waitcnt lgkmcnt(4)
    v_lshlrev_b32 v1, 4, v8
    ds_write_b32 v3, v2 offset:8448
    ds_read_b128 v[8:11], v1
    s_waitcnt lgkmcnt(5)
    v_lshlrev_b32 v1, 4, v12
    ds_write_b32 v3, v2 offset:10496
    ds_read_b128 v[12:15], v1
    s_waitcnt lgkmcnt(6)
    v_lshlrev_b32 v1, 4, v16
    ds_write_b32 v3, v2 offset:12544
    ds_read_b128 v[16:19], v1
    v_mov_b32 v2, 12800
b_wb1:
    s_waitcnt lgkmcnt(3)
    v_lshlrev_b32_sdwa v1, 4, v7 dst_sel:DWORD dst_unused:UNUSED_PAD src0_sel:DWORD src1_sel:WORD_0
    v_lshlrev_b32 v20, 16, v4
    v_lshlrev_b32 v21, 16, v5
    v_lshlrev_b32 v42, 16, v6
    v_and_b32 v24, s34, v4
    v_and_b32 v25, s34, v5
    v_and_b32 v26, s34, v6
    v_and_b32 v27, s34, v7
    ds_read_b128 v[4:7], v1
    v_cmp_ne_u32 vcc, v1, v2
    v_pk_fma_f32 v[44:45], v[20:21], v[42:43], v[44:45] op_sel:[0,0,0] op_sel_hi:[1,0,1]
    v_pk_fma_f32 v[46:47], v[24:25], v[42:43], v[46:47] op_sel:[0,0,0] op_sel_hi:[1,0,1]
    v_pk_fma_f32 v[48:49], v[20:21], v[26:27], v[48:49] op_sel:[0,0,0] op_sel_hi:[1,0,1]
    v_pk_fma_f32 v[50:51], v[24:25], v[26:27], v[50:51] op_sel:[0,0,0] op_sel_hi:[1,0,1]
    v_pk_fma_f32 v[52:53], v[20:21], v[26:27], v[52:53] op_sel:[0,1,0] op_sel_hi:[1,1,1]
    v_pk_fma_f32 v[54:55], v[24:25], v[26:27], v[54:55] op_sel:[0,1,0] op_sel_hi:[1,1,1]
    s_waitcnt lgkmcnt(3)
    v_lshlrev_b32_sdwa v1, 4, v11 dst_sel:DWORD dst_unused:UNUSED_PAD src0_sel:DWORD src1_sel:WORD_0
    v_lshlrev_b32 v20, 16, v8
    v_lshlrev_b32 v21, 16, v9
    v_lshlrev_b32 v42, 16, v10
    v_and_b32 v24, s34, v8
    v_and_b32 v25, s34, v9
    v_and_b32 v26, s34, v10
    v_and_b32 v27, s34, v11
    ds_read_b128 v[8:11], v1
    v_cmp_ne_u32 s[28:29], v1, v2
    v_pk_fma_f32 v[56:57], v[20:21], v[42:43], v[56:57] op_sel:[0,0,0] op_sel_hi:[1,0,1]
    v_pk_fma_f32 v[58:59], v[24:25], v[42:43], v[58:59] op_sel:[0,0,0] op_sel_hi:[1,0,1]
    v_pk_fma_f32 v[60:61], v[20:21], v[26:27], v[60:61] op_sel:[0,0,0] op_sel_hi:[1,0,1]
    v_pk_fma_f32 v[62:63], v[24:25], v[26:27], v[62:63] op_sel:[0,0,0] op_sel_hi:[1,0,1]
    v_pk_fma_f32 v[64:65], v[20:21], v[26:27], v[64:65] op_sel:[0,1,0] op_sel_hi:[1,1,1]
    v_pk_fma_f32 v[66:67], v[24:25], v[26:27], v[66:67] op_sel:[0,1,0] op_sel_hi:[1,1,1]
    s_or_b64 vcc, vcc, s[28:29]
    s_waitcnt lgkmcnt(3)
    v_lshlrev_b32_sdwa v1, 4, v15 dst_sel:DWORD dst_unused:UNUSED_PAD src0_sel:DWORD src1_sel:WORD_0
    v_lshlrev_b32 v20, 16, v12
    v_lshlrev_b32 v21, 16, v13
    v_lshlrev_b32 v42, 16, v14
    v_and_b32 v24, s34, v12
    v_and_b32 v25, s34, v13
    v_and_b32 v26, s34, v14
    v_and_b32 v27, s34, v15
    ds_read_b128 v[12:15], v1
    v_cmp_ne_u32 s[28:29], v1, v2
    v_pk_fma_f32 v[68:69], v[20:21], v[42:43], v[68:69] op_sel:[0,0,0] op_sel_hi:[1,0,1]
    v_pk_fma_f32 v[70:71], v[24:25], v[42:43], v[70:71] op_sel:[0,0,0] op_sel_hi:[1,0,1]
    v_pk_fma_f32 v[72:73], v[20:21], v[26:27], v[72:73] op_sel:[0,0,0] op_sel_hi:[1,0,1]
    v_pk_fma_f32 v[74:75], v[24:25], v[26:27], v[74:75] op_sel:[0,0,0] op_sel_hi:[1,0,1]
    v_pk_fma_f32 v[76:77], v[20:21], v[26:27], v[76:77] op_sel:[0,1,0] op_sel_hi:[1,1,1]
    v_pk_fma_f32 v[78:79], v[24:25], v[26:27], v[78:79] op_sel:[0,1,0] op_sel_hi:[1,1,1]
    s_or_b64 vcc, vcc, s[28:29]
    s_waitcnt lgkmcnt(3)
    v_lshlrev_b32_sdwa v1, 4, v19 dst_sel:DWORD dst_unused:UNUSED_PAD src0_sel:DWORD src1_sel:WORD_0
    v_lshlrev_b32 v20, 16, v16
    v_lshlrev_b32 v21, 16, v17
    v_lshlrev_b32 v42, 16, v18
    v_and_b32 v24, s34, v16
    v_and_b32 v25, s34, v17
    v_and_b32 v26, s34, v18
    v_and_b32 v27, s34, v19
    ds_read_b128 v[16:19], v1
    v_cmp_ne_u32 s[28:29], v1, v2
    v_pk_fma_f32 v[80:81], v[20:21], v[42:43], v[80:81] op_sel:[0,0,0] op_sel_hi:[1,0,1]
    v_pk_fma_f32 v[82:83], v[24:25], v[42:43], v[82:83] op_sel:[0,0,0] op_sel_hi:[1,0,1]
    v_pk_fma_f32 v[84:85], v[20:21], v[26:27], v[84:85] op_sel:[0,0,0] op_sel_hi:[1,0,1]
    v_pk_fma_f32 v[86:87], v[24:25], v[26:27], v[86:87] op_sel:[0,0,0] op_sel_hi:[1,0,1]
    v_pk_fma_f32 v[88:89], v[20:21], v[26:27], v[88:89] op_sel:[0,1,0] op_sel_hi:[1,1,1]
    v_pk_fma_f32 v[90:91], v[24:25], v[26:27], v[90:91] op_sel:[0,1,0] op_sel_hi:[1,1,1]
    s_or_b64 vcc, vcc, s[28:29]
    s_cbranch_vccnz b_wb1
    s_waitcnt lgkmcnt(0)
b_wdone1:
    s_sub_u32 s22, s22, 1
    s_cmp_eq_u32 s22, 0
    s_cbranch_scc1 b_cend
    s_branch b_cloop
b_cend:
    s_waitcnt vmcnt(0)
    s_cmp_lg_u32 s23, 0
    s_cbranch_scc0 b_final
    s_barrier
    s_branch a_batch
b_final:
    s_load_dwordx8 s[16:23], s[100:101], 0
    s_load_dwordx2 s[28:29], s[0:1], 88
    v_lshrrev_b32 v1, 2, v3
    v_add_u32 v1, s25, v1
    v_add_u32 v2, 512, v1
    buffer_load_dwordx2 v[42:43], v1, s[4:7], 0 idxen
    buffer_load_dwordx2 v[124:125], v2, s[4:7], 0 idxen
    v_add_u32 v2, 1024, v1
    s_lshl_b32 s25, s25, 3
    buffer_load_dwordx2 v[126:127], v2, s[4:7], 0 idxen
    v_lshlrev_b32 v3, 1, v3
    s_lshl_b32 s26, s8, 16
    s_and_b32 s27, s8, 0xffff0000
    v_mul_f32 v8, s26, v44
    v_mul_f32 v9, s27, v44
    v_mul_f32 v16, s26, v56
    v_mul_f32 v17, s27, v56
    v_mul_f32 v24, s26, v68
    v_mul_f32 v25, s27, v68
    s_lshl_b32 s26, s9, 16
    s_and_b32 s27, s9, 0xffff0000
    v_mul_f32 v10, s26, v44
    v_mul_f32 v11, s27, v44
    v_mul_f32 v18, s26, v56
    v_mul_f32 v19, s27, v56
    v_mul_f32 v26, s26, v68
    v_mul_f32 v27, s27, v68
    s_lshl_b32 s26, s10, 16
    s_and_b32 s27, s10, 0xffff0000
    v_fmac_f32 v8, s26, v46
    v_fmac_f32 v9, s27, v46
    v_fmac_f32 v16, s26, v58
    v_fmac_f32 v17, s27, v58
    v_fmac_f32 v24, s26, v70
    v_fmac_f32 v25, s27, v70
    s_lshl_b32 s26, s11, 16
    s_and_b32 s27, s11, 0xffff0000
    v_fmac_f32 v10, s26, v46
    v_fmac_f32 v11, s27, v46
    v_fmac_f32 v18, s26, v58
    v_fmac_f32 v19, s27, v58
    v_fmac_f32 v26, s26, v70
    v_fmac_f32 v27, s27, v70
    s_lshl_b32 s26, s12, 16
    s_and_b32 s27, s12, 0xffff0000
    v_fmac_f32 v8, s26, v45
    v_fmac_f32 v9, s27, v45
    v_fmac_f32 v16, s26, v57
    v_fmac_f32 v17, s27, v57
    v_fmac_f32 v24, s26, v69
    v_fmac_f32 v25, s27, v69
    s_lshl_b32 s26, s13, 16
    s_and_b32 s27, s13, 0xffff0000
    v_fmac_f32 v10, s26, v45
    v_fmac_f32 v11, s27, v45
    v_fmac_f32 v18, s26, v57
    v_fmac_f32 v19, s27, v57
    v_fmac_f32 v26, s26, v69
    v_fmac_f32 v27, s27, v69
    s_lshl_b32 s26, s14, 16
    s_and_b32 s27, s14, 0xffff0000
    v_fmac_f32 v8, s26, v47
    v_fmac_f32 v9, s27, v47
    v_fmac_f32 v16, s26, v59
    v_fmac_f32 v17, s27, v59
    v_fmac_f32 v24, s26, v71
    v_fmac_f32 v25, s27, v71
    s_lshl_b32 s26, s15, 16
    s_and_b32 s27, s15, 0xffff0000
    v_fmac_f32 v10, s26, v47
    v_fmac_f32 v11, s27, v47
    v_fmac_f32 v18, s26, v59
    v_fmac_f32 v19, s27, v59
    v_fmac_f32 v26, s26, v71
    v_fmac_f32 v27, s27, v71
    v_mul_f32 v4, v28, v8
    v_mul_f32 v5, v29, v9
    v_mul_f32 v6, v30, v10
    v_mul_f32 v7, v31, v11
    v_mul_f32 v12, v92, v16
    v_mul_f32 v13, v93, v17
    v_mul_f32 v14, v94, v18
    v_mul_f32 v15, v95, v19
    v_mul_f32 v20, v106, v24
    v_mul_f32 v21, v107, v25
    v_mul_f32 v22, v108, v26
    v_mul_f32 v23, v109, v27
    s_lshl_b32 s26, s8, 16
    s_and_b32 s27, s8, 0xffff0000
    v_mul_f32 v8, s26, v48
    v_mul_f32 v9, s27, v48
    v_mul_f32 v16, s26, v60
    v_mul_f32 v17, s27, v60
    v_mul_f32 v24, s26, v72
    v_mul_f32 v25, s27, v72
    s_lshl_b32 s26, s9, 16
    s_and_b32 s27, s9, 0xffff0000
    v_mul_f32 v10, s26, v48
    v_mul_f32 v11, s27, v48
    v_mul_f32 v18, s26, v60
    v_mul_f32 v19, s27, v60
    v_mul_f32 v26, s26, v72
    v_mul_f32 v27, s27, v72
    s_lshl_b32 s26, s10, 16
    s_and_b32 s27, s10, 0xffff0000
    v_fmac_f32 v8, s26, v50
    v_fmac_f32 v9, s27, v50
    v_fmac_f32 v16, s26, v62
    v_fmac_f32 v17, s27, v62
    v_fmac_f32 v24, s26, v74
    v_fmac_f32 v25, s27, v74
    s_lshl_b32 s26, s11, 16
    s_and_b32 s27, s11, 0xffff0000
    v_fmac_f32 v10, s26, v50
    v_fmac_f32 v11, s27, v50
    v_fmac_f32 v18, s26, v62
    v_fmac_f32 v19, s27, v62
    v_fmac_f32 v26, s26, v74
    v_fmac_f32 v27, s27, v74
    s_lshl_b32 s26, s12, 16
    s_and_b32 s27, s12, 0xffff0000
    v_fmac_f32 v8, s26, v49
    v_fmac_f32 v9, s27, v49
    v_fmac_f32 v16, s26, v61
    v_fmac_f32 v17, s27, v61
    v_fmac_f32 v24, s26, v73
    v_fmac_f32 v25, s27, v73
    s_lshl_b32 s26, s13, 16
    s_and_b32 s27, s13, 0xffff0000
    v_fmac_f32 v10, s26, v49
    v_fmac_f32 v11, s27, v49
    v_fmac_f32 v18, s26, v61
    v_fmac_f32 v19, s27, v61
    v_fmac_f32 v26, s26, v73
    v_fmac_f32 v27, s27, v73
    s_lshl_b32 s26, s14, 16
    s_and_b32 s27, s14, 0xffff0000
    v_fmac_f32 v8, s26, v51
    v_fmac_f32 v9, s27, v51
    v_fmac_f32 v16, s26, v63
    v_fmac_f32 v17, s27, v63
    v_fmac_f32 v24, s26, v75
    v_fmac_f32 v25, s27, v75
    s_lshl_b32 s26, s15, 16
    s_and_b32 s27, s15, 0xffff0000
    v_fmac_f32 v10, s26, v51
    v_fmac_f32 v11, s27, v51
    v_fmac_f32 v18, s26, v63
    v_fmac_f32 v19, s27, v63
    v_fmac_f32 v26, s26, v75
    v_fmac_f32 v27, s27, v75
    v_fmac_f32 v4, v32, v8
    v_fmac_f32 v5, v33, v9
    v_fmac_f32 v6, v34, v10
    v_fmac_f32 v7, v35, v11
    v_fmac_f32 v12, v96, v16
    v_fmac_f32 v13, v97, v17
    v_fmac_f32 v14, v98, v18
    v_fmac_f32 v15, v99, v19
    v_fmac_f32 v20, v110, v24
    v_fmac_f32 v21, v111, v25
    v_fmac_f32 v22, v112, v26
    v_fmac_f32 v23, v113, v27
    s_lshl_b32 s26, s8, 16
    s_and_b32 s27, s8, 0xffff0000
    v_mul_f32 v8, s26, v52
    v_mul_f32 v9, s27, v52
    v_mul_f32 v16, s26, v64
    v_mul_f32 v17, s27, v64
    v_mul_f32 v24, s26, v76
    v_mul_f32 v25, s27, v76
    s_lshl_b32 s26, s9, 16
    s_and_b32 s27, s9, 0xffff0000
    v_mul_f32 v10, s26, v52
    v_mul_f32 v11, s27, v52
    v_mul_f32 v18, s26, v64
    v_mul_f32 v19, s27, v64
    v_mul_f32 v26, s26, v76
    v_mul_f32 v27, s27, v76
    s_lshl_b32 s26, s10, 16
    s_and_b32 s27, s10, 0xffff0000
    v_fmac_f32 v8, s26, v54
    v_fmac_f32 v9, s27, v54
    v_fmac_f32 v16, s26, v66
    v_fmac_f32 v17, s27, v66
    v_fmac_f32 v24, s26, v78
    v_fmac_f32 v25, s27, v78
    s_lshl_b32 s26, s11, 16
    s_and_b32 s27, s11, 0xffff0000
    v_fmac_f32 v10, s26, v54
    v_fmac_f32 v11, s27, v54
    v_fmac_f32 v18, s26, v66
    v_fmac_f32 v19, s27, v66
    v_fmac_f32 v26, s26, v78
    v_fmac_f32 v27, s27, v78
    s_lshl_b32 s26, s12, 16
    s_and_b32 s27, s12, 0xffff0000
    v_fmac_f32 v8, s26, v53
    v_fmac_f32 v9, s27, v53
    v_fmac_f32 v16, s26, v65
    v_fmac_f32 v17, s27, v65
    v_fmac_f32 v24, s26, v77
    v_fmac_f32 v25, s27, v77
    s_lshl_b32 s26, s13, 16
    s_and_b32 s27, s13, 0xffff0000
    v_fmac_f32 v10, s26, v53
    v_fmac_f32 v11, s27, v53
    v_fmac_f32 v18, s26, v65
    v_fmac_f32 v19, s27, v65
    v_fmac_f32 v26, s26, v77
    v_fmac_f32 v27, s27, v77
    s_lshl_b32 s26, s14, 16
    s_and_b32 s27, s14, 0xffff0000
    v_fmac_f32 v8, s26, v55
    v_fmac_f32 v9, s27, v55
    v_fmac_f32 v16, s26, v67
    v_fmac_f32 v17, s27, v67
    v_fmac_f32 v24, s26, v79
    v_fmac_f32 v25, s27, v79
    s_lshl_b32 s26, s15, 16
    s_and_b32 s27, s15, 0xffff0000
    v_fmac_f32 v10, s26, v55
    v_fmac_f32 v11, s27, v55
    v_fmac_f32 v18, s26, v67
    v_fmac_f32 v19, s27, v67
    v_fmac_f32 v26, s26, v79
    v_fmac_f32 v27, s27, v79
    v_fmac_f32 v4, v36, v8
    v_fmac_f32 v5, v37, v9
    v_fmac_f32 v6, v38, v10
    v_fmac_f32 v7, v39, v11
    v_fmac_f32 v12, v100, v16
    v_fmac_f32 v13, v101, v17
    v_fmac_f32 v14, v102, v18
    v_fmac_f32 v15, v103, v19
    v_fmac_f32 v20, v114, v24
    v_fmac_f32 v21, v115, v25
    v_fmac_f32 v22, v116, v26
    v_fmac_f32 v23, v117, v27
    s_waitcnt lgkmcnt(0)
    s_and_b32 s29, s29, 0xffff
    s_mov_b32 s30, 3200000
    s_mov_b32 s31, 0x00020000
    s_lshl_b32 s26, s16, 16
    s_and_b32 s27, s16, 0xffff0000
    v_mul_f32 v8, s26, v4
    v_mul_f32 v9, s27, v4
    v_mul_f32 v16, s26, v12
    v_mul_f32 v17, s27, v12
    v_mul_f32 v24, s26, v20
    v_mul_f32 v25, s27, v20
    s_lshl_b32 s26, s17, 16
    s_and_b32 s27, s17, 0xffff0000
    v_mul_f32 v10, s26, v4
    v_mul_f32 v11, s27, v4
    v_mul_f32 v18, s26, v12
    v_mul_f32 v19, s27, v12
    v_mul_f32 v26, s26, v20
    v_mul_f32 v27, s27, v20
    s_lshl_b32 s26, s18, 16
    s_and_b32 s27, s18, 0xffff0000
    v_fmac_f32 v8, s26, v5
    v_fmac_f32 v9, s27, v5
    v_fmac_f32 v16, s26, v13
    v_fmac_f32 v17, s27, v13
    v_fmac_f32 v24, s26, v21
    v_fmac_f32 v25, s27, v21
    s_lshl_b32 s26, s19, 16
    s_and_b32 s27, s19, 0xffff0000
    v_fmac_f32 v10, s26, v5
    v_fmac_f32 v11, s27, v5
    v_fmac_f32 v18, s26, v13
    v_fmac_f32 v19, s27, v13
    v_fmac_f32 v26, s26, v21
    v_fmac_f32 v27, s27, v21
    s_lshl_b32 s26, s20, 16
    s_and_b32 s27, s20, 0xffff0000
    v_fmac_f32 v8, s26, v6
    v_fmac_f32 v9, s27, v6
    v_fmac_f32 v16, s26, v14
    v_fmac_f32 v17, s27, v14
    v_fmac_f32 v24, s26, v22
    v_fmac_f32 v25, s27, v22
    s_lshl_b32 s26, s21, 16
    s_and_b32 s27, s21, 0xffff0000
    v_fmac_f32 v10, s26, v6
    v_fmac_f32 v11, s27, v6
    v_fmac_f32 v18, s26, v14
    v_fmac_f32 v19, s27, v14
    v_fmac_f32 v26, s26, v22
    v_fmac_f32 v27, s27, v22
    s_lshl_b32 s26, s22, 16
    s_and_b32 s27, s22, 0xffff0000
    v_fmac_f32 v8, s26, v7
    v_fmac_f32 v9, s27, v7
    v_fmac_f32 v16, s26, v15
    v_fmac_f32 v17, s27, v15
    v_fmac_f32 v24, s26, v23
    v_fmac_f32 v25, s27, v23
    s_lshl_b32 s26, s23, 16
    s_and_b32 s27, s23, 0xffff0000
    v_fmac_f32 v10, s26, v7
    v_fmac_f32 v11, s27, v7
    v_fmac_f32 v18, s26, v15
    v_fmac_f32 v19, s27, v15
    v_fmac_f32 v26, s26, v23
    v_fmac_f32 v27, s27, v23
    s_waitcnt vmcnt(0)
    v_cvt_pk_bf16_f32 v9, v8, v9
    v_lshlrev_b32 v4, 16, v40
    v_and_b32 v5, 0xffff0000, v40
    v_lshlrev_b32 v8, 16, v9
    v_and_b32 v9, 0xffff0000, v9
    v_mul_f32 v8, v8, v4
    v_mul_f32 v9, v9, v5
    v_cvt_pk_bf16_f32 v9, v8, v9
    v_lshlrev_b32 v4, 16, v42
    v_and_b32 v5, 0xffff0000, v42
    v_lshlrev_b32 v8, 16, v9
    v_and_b32 v9, 0xffff0000, v9
    v_add_f32 v8, v8, v4
    v_add_f32 v9, v9, v5
    v_cvt_pk_bf16_f32 v40, v8, v9
    v_cvt_pk_bf16_f32 v11, v10, v11
    v_lshlrev_b32 v4, 16, v41
    v_and_b32 v5, 0xffff0000, v41
    v_lshlrev_b32 v10, 16, v11
    v_and_b32 v11, 0xffff0000, v11
    v_mul_f32 v10, v10, v4
    v_mul_f32 v11, v11, v5
    v_cvt_pk_bf16_f32 v11, v10, v11
    v_lshlrev_b32 v4, 16, v43
    v_and_b32 v5, 0xffff0000, v43
    v_lshlrev_b32 v10, 16, v11
    v_and_b32 v11, 0xffff0000, v11
    v_add_f32 v10, v10, v4
    v_add_f32 v11, v11, v5
    v_cvt_pk_bf16_f32 v41, v10, v11
    s_add_u32 s26, s25, 0
    buffer_store_dwordx2 v[40:41], v3, s[28:31], s26 offen
    v_cvt_pk_bf16_f32 v17, v16, v17
    v_lshlrev_b32 v12, 16, v104
    v_and_b32 v13, 0xffff0000, v104
    v_lshlrev_b32 v16, 16, v17
    v_and_b32 v17, 0xffff0000, v17
    v_mul_f32 v16, v16, v12
    v_mul_f32 v17, v17, v13
    v_cvt_pk_bf16_f32 v17, v16, v17
    v_lshlrev_b32 v12, 16, v124
    v_and_b32 v13, 0xffff0000, v124
    v_lshlrev_b32 v16, 16, v17
    v_and_b32 v17, 0xffff0000, v17
    v_add_f32 v16, v16, v12
    v_add_f32 v17, v17, v13
    v_cvt_pk_bf16_f32 v104, v16, v17
    v_cvt_pk_bf16_f32 v19, v18, v19
    v_lshlrev_b32 v12, 16, v105
    v_and_b32 v13, 0xffff0000, v105
    v_lshlrev_b32 v18, 16, v19
    v_and_b32 v19, 0xffff0000, v19
    v_mul_f32 v18, v18, v12
    v_mul_f32 v19, v19, v13
    v_cvt_pk_bf16_f32 v19, v18, v19
    v_lshlrev_b32 v12, 16, v125
    v_and_b32 v13, 0xffff0000, v125
    v_lshlrev_b32 v18, 16, v19
    v_and_b32 v19, 0xffff0000, v19
    v_add_f32 v18, v18, v12
    v_add_f32 v19, v19, v13
    v_cvt_pk_bf16_f32 v105, v18, v19
    s_add_u32 s26, s25, 4096
    buffer_store_dwordx2 v[104:105], v3, s[28:31], s26 offen
    v_cvt_pk_bf16_f32 v25, v24, v25
    v_lshlrev_b32 v20, 16, v118
    v_and_b32 v21, 0xffff0000, v118
    v_lshlrev_b32 v24, 16, v25
    v_and_b32 v25, 0xffff0000, v25
    v_mul_f32 v24, v24, v20
    v_mul_f32 v25, v25, v21
    v_cvt_pk_bf16_f32 v25, v24, v25
    v_lshlrev_b32 v20, 16, v126
    v_and_b32 v21, 0xffff0000, v126
    v_lshlrev_b32 v24, 16, v25
    v_and_b32 v25, 0xffff0000, v25
    v_add_f32 v24, v24, v20
    v_add_f32 v25, v25, v21
    v_cvt_pk_bf16_f32 v118, v24, v25
    v_cvt_pk_bf16_f32 v27, v26, v27
    v_lshlrev_b32 v20, 16, v119
    v_and_b32 v21, 0xffff0000, v119
    v_lshlrev_b32 v26, 16, v27
    v_and_b32 v27, 0xffff0000, v27
    v_mul_f32 v26, v26, v20
    v_mul_f32 v27, v27, v21
    v_cvt_pk_bf16_f32 v27, v26, v27
    v_lshlrev_b32 v20, 16, v127
    v_and_b32 v21, 0xffff0000, v127
    v_lshlrev_b32 v26, 16, v27
    v_and_b32 v27, 0xffff0000, v27
    v_add_f32 v26, v26, v20
    v_add_f32 v27, v27, v21
    v_cvt_pk_bf16_f32 v119, v26, v27
    s_add_u32 s26, s25, 8192
    buffer_store_dwordx2 v[118:119], v3, s[28:31], s26 offen
    s_cmp_lg_u32 s3, 8
    s_cbranch_scc1 b_fin_done
    v_cmp_gt_u32 vcc, 216, v3
    v_add_u32 v2, 1536, v1
    buffer_load_dwordx2 v[42:43], v2, s[4:7], 0 idxen
    v_cndmask_b32 v3, 2.0, v3, vcc
    s_pack_ll_b32_b16 s26, s84, s86
    s_pack_hh_b32_b16 s27, s84, s86
    v_dot2_f32_bf16 v60, v120, s26, 0
    v_dot2_f32_bf16 v61, v120, s27, 0
    s_pack_ll_b32_b16 s26, s85, s87
    s_pack_hh_b32_b16 s27, s85, s87
    v_dot2_f32_bf16 v62, v120, s26, 0
    v_dot2_f32_bf16 v63, v120, s27, 0
    s_pack_ll_b32_b16 s26, s88, s90
    s_pack_hh_b32_b16 s27, s88, s90
    v_dot2_f32_bf16 v60, v121, s26, v60
    v_dot2_f32_bf16 v61, v121, s27, v61
    s_pack_ll_b32_b16 s26, s89, s91
    s_pack_hh_b32_b16 s27, s89, s91
    v_dot2_f32_bf16 v62, v121, s26, v62
    v_dot2_f32_bf16 v63, v121, s27, v63
    s_pack_ll_b32_b16 s26, s92, s94
    s_pack_hh_b32_b16 s27, s92, s94
    v_dot2_f32_bf16 v60, v122, s26, v60
    v_dot2_f32_bf16 v61, v122, s27, v61
    s_pack_ll_b32_b16 s26, s93, s95
    s_pack_hh_b32_b16 s27, s93, s95
    v_dot2_f32_bf16 v62, v122, s26, v62
    v_dot2_f32_bf16 v63, v122, s27, v63
    s_pack_ll_b32_b16 s26, s96, s98
    s_pack_hh_b32_b16 s27, s96, s98
    v_dot2_f32_bf16 v60, v123, s26, v60
    v_dot2_f32_bf16 v61, v123, s27, v61
    s_pack_ll_b32_b16 s26, s97, s99
    s_pack_hh_b32_b16 s27, s97, s99
    v_dot2_f32_bf16 v62, v123, s26, v62
    v_dot2_f32_bf16 v63, v123, s27, v63
    s_pack_ll_b32_b16 s26, s36, s42
    s_pack_hh_b32_b16 s27, s36, s42
    v_dot2_f32_bf16 v44, v120, s26, 0
    v_dot2_f32_bf16 v45, v120, s27, 0
    s_pack_ll_b32_b16 s26, s37, s43
    s_pack_hh_b32_b16 s27, s37, s43
    v_dot2_f32_bf16 v46, v120, s26, 0
    v_dot2_f32_bf16 v47, v120, s27, 0
    s_pack_ll_b32_b16 s26, s48, s54
    s_pack_hh_b32_b16 s27, s48, s54
    v_dot2_f32_bf16 v44, v121, s26, v44
    v_dot2_f32_bf16 v45, v121, s27, v45
    s_pack_ll_b32_b16 s26, s49, s55
    s_pack_hh_b32_b16 s27, s49, s55
    v_dot2_f32_bf16 v46, v121, s26, v46
    v_dot2_f32_bf16 v47, v121, s27, v47
    s_pack_ll_b32_b16 s26, s60, s66
    s_pack_hh_b32_b16 s27, s60, s66
    v_dot2_f32_bf16 v44, v122, s26, v44
    v_dot2_f32_bf16 v45, v122, s27, v45
    s_pack_ll_b32_b16 s26, s61, s67
    s_pack_hh_b32_b16 s27, s61, s67
    v_dot2_f32_bf16 v46, v122, s26, v46
    v_dot2_f32_bf16 v47, v122, s27, v47
    s_pack_ll_b32_b16 s26, s72, s78
    s_pack_hh_b32_b16 s27, s72, s78
    v_dot2_f32_bf16 v44, v123, s26, v44
    v_dot2_f32_bf16 v45, v123, s27, v45
    s_pack_ll_b32_b16 s26, s73, s79
    s_pack_hh_b32_b16 s27, s73, s79
    v_dot2_f32_bf16 v46, v123, s26, v46
    v_dot2_f32_bf16 v47, v123, s27, v47
    s_pack_ll_b32_b16 s26, s38, s44
    s_pack_hh_b32_b16 s27, s38, s44
    v_dot2_f32_bf16 v48, v120, s26, 0
    v_dot2_f32_bf16 v49, v120, s27, 0
    s_pack_ll_b32_b16 s26, s39, s45
    s_pack_hh_b32_b16 s27, s39, s45
    v_dot2_f32_bf16 v50, v120, s26, 0
    v_dot2_f32_bf16 v51, v120, s27, 0
    s_pack_ll_b32_b16 s26, s50, s56
    s_pack_hh_b32_b16 s27, s50, s56
    v_dot2_f32_bf16 v48, v121, s26, v48
    v_dot2_f32_bf16 v49, v121, s27, v49
    s_pack_ll_b32_b16 s26, s51, s57
    s_pack_hh_b32_b16 s27, s51, s57
    v_dot2_f32_bf16 v50, v121, s26, v50
    v_dot2_f32_bf16 v51, v121, s27, v51
    s_pack_ll_b32_b16 s26, s62, s68
    s_pack_hh_b32_b16 s27, s62, s68
    v_dot2_f32_bf16 v48, v122, s26, v48
    v_dot2_f32_bf16 v49, v122, s27, v49
    s_pack_ll_b32_b16 s26, s63, s69
    s_pack_hh_b32_b16 s27, s63, s69
    v_dot2_f32_bf16 v50, v122, s26, v50
    v_dot2_f32_bf16 v51, v122, s27, v51
    s_pack_ll_b32_b16 s26, s74, s80
    s_pack_hh_b32_b16 s27, s74, s80
    v_dot2_f32_bf16 v48, v123, s26, v48
    v_dot2_f32_bf16 v49, v123, s27, v49
    s_pack_ll_b32_b16 s26, s75, s81
    s_pack_hh_b32_b16 s27, s75, s81
    v_dot2_f32_bf16 v50, v123, s26, v50
    v_dot2_f32_bf16 v51, v123, s27, v51
    s_pack_ll_b32_b16 s26, s40, s46
    s_pack_hh_b32_b16 s27, s40, s46
    v_dot2_f32_bf16 v52, v120, s26, 0
    v_dot2_f32_bf16 v53, v120, s27, 0
    s_pack_ll_b32_b16 s26, s41, s47
    s_pack_hh_b32_b16 s27, s41, s47
    v_dot2_f32_bf16 v54, v120, s26, 0
    v_dot2_f32_bf16 v55, v120, s27, 0
    s_pack_ll_b32_b16 s26, s52, s58
    s_pack_hh_b32_b16 s27, s52, s58
    v_dot2_f32_bf16 v52, v121, s26, v52
    v_dot2_f32_bf16 v53, v121, s27, v53
    s_pack_ll_b32_b16 s26, s53, s59
    s_pack_hh_b32_b16 s27, s53, s59
    v_dot2_f32_bf16 v54, v121, s26, v54
    v_dot2_f32_bf16 v55, v121, s27, v55
    s_pack_ll_b32_b16 s26, s64, s70
    s_pack_hh_b32_b16 s27, s64, s70
    v_dot2_f32_bf16 v52, v122, s26, v52
    v_dot2_f32_bf16 v53, v122, s27, v53
    s_pack_ll_b32_b16 s26, s65, s71
    s_pack_hh_b32_b16 s27, s65, s71
    v_dot2_f32_bf16 v54, v122, s26, v54
    v_dot2_f32_bf16 v55, v122, s27, v55
    s_pack_ll_b32_b16 s26, s76, s82
    s_pack_hh_b32_b16 s27, s76, s82
    v_dot2_f32_bf16 v52, v123, s26, v52
    v_dot2_f32_bf16 v53, v123, s27, v53
    s_pack_ll_b32_b16 s26, s77, s83
    s_pack_hh_b32_b16 s27, s77, s83
    v_dot2_f32_bf16 v54, v123, s26, v54
    v_dot2_f32_bf16 v55, v123, s27, v55
    v_cvt_pk_bf16_f32 v56, v60, v61
    v_cvt_pk_bf16_f32 v57, v62, v63
    s_nop 2
    s_lshl_b32 s26, s8, 16
    s_and_b32 s27, s8, 0xffff0000
    v_mul_f32 v8, s26, v80
    v_mul_f32 v9, s27, v80
    s_lshl_b32 s26, s9, 16
    s_and_b32 s27, s9, 0xffff0000
    v_mul_f32 v10, s26, v80
    v_mul_f32 v11, s27, v80
    s_lshl_b32 s26, s10, 16
    s_and_b32 s27, s10, 0xffff0000
    v_fmac_f32 v8, s26, v82
    v_fmac_f32 v9, s27, v82
    s_lshl_b32 s26, s11, 16
    s_and_b32 s27, s11, 0xffff0000
    v_fmac_f32 v10, s26, v82
    v_fmac_f32 v11, s27, v82
    s_lshl_b32 s26, s12, 16
    s_and_b32 s27, s12, 0xffff0000
    v_fmac_f32 v8, s26, v81
    v_fmac_f32 v9, s27, v81
    s_lshl_b32 s26, s13, 16
    s_and_b32 s27, s13, 0xffff0000
    v_fmac_f32 v10, s26, v81
    v_fmac_f32 v11, s27, v81
    s_lshl_b32 s26, s14, 16
    s_and_b32 s27, s14, 0xffff0000
    v_fmac_f32 v8, s26, v83
    v_fmac_f32 v9, s27, v83
    s_lshl_b32 s26, s15, 16
    s_and_b32 s27, s15, 0xffff0000
    v_fmac_f32 v10, s26, v83
    v_fmac_f32 v11, s27, v83
    v_mul_f32 v4, v44, v8
    v_mul_f32 v5, v45, v9
    v_mul_f32 v6, v46, v10
    v_mul_f32 v7, v47, v11
    s_lshl_b32 s26, s8, 16
    s_and_b32 s27, s8, 0xffff0000
    v_mul_f32 v8, s26, v84
    v_mul_f32 v9, s27, v84
    s_lshl_b32 s26, s9, 16
    s_and_b32 s27, s9, 0xffff0000
    v_mul_f32 v10, s26, v84
    v_mul_f32 v11, s27, v84
    s_lshl_b32 s26, s10, 16
    s_and_b32 s27, s10, 0xffff0000
    v_fmac_f32 v8, s26, v86
    v_fmac_f32 v9, s27, v86
    s_lshl_b32 s26, s11, 16
    s_and_b32 s27, s11, 0xffff0000
    v_fmac_f32 v10, s26, v86
    v_fmac_f32 v11, s27, v86
    s_lshl_b32 s26, s12, 16
    s_and_b32 s27, s12, 0xffff0000
    v_fmac_f32 v8, s26, v85
    v_fmac_f32 v9, s27, v85
    s_lshl_b32 s26, s13, 16
    s_and_b32 s27, s13, 0xffff0000
    v_fmac_f32 v10, s26, v85
    v_fmac_f32 v11, s27, v85
    s_lshl_b32 s26, s14, 16
    s_and_b32 s27, s14, 0xffff0000
    v_fmac_f32 v8, s26, v87
    v_fmac_f32 v9, s27, v87
    s_lshl_b32 s26, s15, 16
    s_and_b32 s27, s15, 0xffff0000
    v_fmac_f32 v10, s26, v87
    v_fmac_f32 v11, s27, v87
    v_fmac_f32 v4, v48, v8
    v_fmac_f32 v5, v49, v9
    v_fmac_f32 v6, v50, v10
    v_fmac_f32 v7, v51, v11
    s_lshl_b32 s26, s8, 16
    s_and_b32 s27, s8, 0xffff0000
    v_mul_f32 v8, s26, v88
    v_mul_f32 v9, s27, v88
    s_lshl_b32 s26, s9, 16
    s_and_b32 s27, s9, 0xffff0000
    v_mul_f32 v10, s26, v88
    v_mul_f32 v11, s27, v88
    s_lshl_b32 s26, s10, 16
    s_and_b32 s27, s10, 0xffff0000
    v_fmac_f32 v8, s26, v90
    v_fmac_f32 v9, s27, v90
    s_lshl_b32 s26, s11, 16
    s_and_b32 s27, s11, 0xffff0000
    v_fmac_f32 v10, s26, v90
    v_fmac_f32 v11, s27, v90
    s_lshl_b32 s26, s12, 16
    s_and_b32 s27, s12, 0xffff0000
    v_fmac_f32 v8, s26, v89
    v_fmac_f32 v9, s27, v89
    s_lshl_b32 s26, s13, 16
    s_and_b32 s27, s13, 0xffff0000
    v_fmac_f32 v10, s26, v89
    v_fmac_f32 v11, s27, v89
    s_lshl_b32 s26, s14, 16
    s_and_b32 s27, s14, 0xffff0000
    v_fmac_f32 v8, s26, v91
    v_fmac_f32 v9, s27, v91
    s_lshl_b32 s26, s15, 16
    s_and_b32 s27, s15, 0xffff0000
    v_fmac_f32 v10, s26, v91
    v_fmac_f32 v11, s27, v91
    v_fmac_f32 v4, v52, v8
    v_fmac_f32 v5, v53, v9
    v_fmac_f32 v6, v54, v10
    v_fmac_f32 v7, v55, v11
    s_lshl_b32 s26, s16, 16
    s_and_b32 s27, s16, 0xffff0000
    v_mul_f32 v8, s26, v4
    v_mul_f32 v9, s27, v4
    s_lshl_b32 s26, s17, 16
    s_and_b32 s27, s17, 0xffff0000
    v_mul_f32 v10, s26, v4
    v_mul_f32 v11, s27, v4
    s_lshl_b32 s26, s18, 16
    s_and_b32 s27, s18, 0xffff0000
    v_fmac_f32 v8, s26, v5
    v_fmac_f32 v9, s27, v5
    s_lshl_b32 s26, s19, 16
    s_and_b32 s27, s19, 0xffff0000
    v_fmac_f32 v10, s26, v5
    v_fmac_f32 v11, s27, v5
    s_lshl_b32 s26, s20, 16
    s_and_b32 s27, s20, 0xffff0000
    v_fmac_f32 v8, s26, v6
    v_fmac_f32 v9, s27, v6
    s_lshl_b32 s26, s21, 16
    s_and_b32 s27, s21, 0xffff0000
    v_fmac_f32 v10, s26, v6
    v_fmac_f32 v11, s27, v6
    s_lshl_b32 s26, s22, 16
    s_and_b32 s27, s22, 0xffff0000
    v_fmac_f32 v8, s26, v7
    v_fmac_f32 v9, s27, v7
    s_lshl_b32 s26, s23, 16
    s_and_b32 s27, s23, 0xffff0000
    v_fmac_f32 v10, s26, v7
    v_fmac_f32 v11, s27, v7
    s_waitcnt vmcnt(0)
    v_cvt_pk_bf16_f32 v9, v8, v9
    v_lshlrev_b32 v4, 16, v56
    v_and_b32 v5, 0xffff0000, v56
    v_lshlrev_b32 v8, 16, v9
    v_and_b32 v9, 0xffff0000, v9
    v_mul_f32 v8, v8, v4
    v_mul_f32 v9, v9, v5
    v_cvt_pk_bf16_f32 v9, v8, v9
    v_lshlrev_b32 v4, 16, v42
    v_and_b32 v5, 0xffff0000, v42
    v_lshlrev_b32 v8, 16, v9
    v_and_b32 v9, 0xffff0000, v9
    v_add_f32 v8, v8, v4
    v_add_f32 v9, v9, v5
    v_cvt_pk_bf16_f32 v56, v8, v9
    v_cvt_pk_bf16_f32 v11, v10, v11
    v_lshlrev_b32 v4, 16, v57
    v_and_b32 v5, 0xffff0000, v57
    v_lshlrev_b32 v10, 16, v11
    v_and_b32 v11, 0xffff0000, v11
    v_mul_f32 v10, v10, v4
    v_mul_f32 v11, v11, v5
    v_cvt_pk_bf16_f32 v11, v10, v11
    v_lshlrev_b32 v4, 16, v43
    v_and_b32 v5, 0xffff0000, v43
    v_lshlrev_b32 v10, 16, v11
    v_and_b32 v11, 0xffff0000, v11
    v_add_f32 v10, v10, v4
    v_add_f32 v11, v11, v5
    v_cvt_pk_bf16_f32 v57, v10, v11
    s_add_u32 s26, s25, 12288
    buffer_store_dwordx2 v[56:57], v3, s[28:31], s26 offen
b_fin_done:
p2_done:
    s_endpgm
.section .rodata,"a"
.p2align 6
.amdhsa_kernel acc_kernel
  .amdhsa_next_free_vgpr 128
  .amdhsa_next_free_sgpr 102
  .amdhsa_accum_offset 128
  .amdhsa_group_segment_fixed_size 0
  .amdhsa_kernarg_size 112
  .amdhsa_user_sgpr_count 2
  .amdhsa_user_sgpr_kernarg_segment_ptr 1
  .amdhsa_system_sgpr_workgroup_id_x 1
  .amdhsa_float_denorm_mode_32 3
.end_amdhsa_kernel
.text
```
